```python
import torch

def _softmax(x, axis=-1):
    return torch.softmax(x, dim=axis)
def _gelu(x):
    return torch.nn.functional.gelu(x, approximate="tanh")
def _silu(x):
    return torch.nn.functional.silu(x)
def _sigmoid(x):
    return torch.sigmoid(x)
def _layernorm(x, axis=-1, eps=1e-5):
    m = x.mean(dim=axis, keepdim=True)
    v = x.var(dim=axis, keepdim=True, unbiased=False)
    return (x - m) / torch.sqrt(v + eps)
def _scatter_add(tgt, idx, src, axis=0):
    return tgt.clone().index_add_(axis, idx, src)
def _segment_sum(src, seg, n):
    out = torch.zeros((n,) + src.shape[1:], dtype=src.dtype)
    return out.index_add_(0, seg, src)
def _pad(x, pw):
    flat = tuple(v for pair in reversed(pw) for v in pair)
    return torch.nn.functional.pad(x, flat)

kernel_name = 'recurrent_scan__linear_kernel_hedgehog__dense_activation_mish__prompt'

def setup_inputs():

    _w = (lambda a: (lambda t: t.to(torch.bfloat16) if t.is_floating_point() else t)(torch.as_tensor(a)))
    def _A_setup():
        B, S, D, H = 1, 2048, 512, 32
        Dh = D // H
        return {
            "x": _w((lambda *s: torch.randn(*s, dtype=torch.bfloat16) * 0.05)(B, S, D)),
            "wqkv": _w((lambda *s: torch.randn(*s, dtype=torch.bfloat16) * 0.4)(D, 3 * D)),
            "w_phi": _w((lambda *s: torch.randn(*s, dtype=torch.bfloat16) * 0.4)(H, Dh, Dh) * (Dh ** -0.5)),
            "wo": _w((lambda *s: torch.randn(*s, dtype=torch.bfloat16) * 0.2)(D, D)),
        }
    _A_in = _A_setup()

    def _B_setup():
        B, S, D, F = 1, 2048, 512, 1792
        return {
            "x": _w((lambda *s: torch.randn(*s, dtype=torch.bfloat16) * 0.05)(B, S, D)),
            "w1": _w((lambda *s: torch.randn(*s, dtype=torch.bfloat16) * 0.4)(D, F) * (D ** -0.5)),
            "b1": _w((lambda *s: torch.randn(*s, dtype=torch.bfloat16) * 0.1)(F)),
            "w2": _w((lambda *s: torch.randn(*s, dtype=torch.bfloat16) * 0.1)(F, D) * (F ** -0.5)),
        }
    _B_in = _B_setup()

    return {
        "A_x": _A_in["x"],
        "A_wqkv": _A_in["wqkv"],
        "A_w_phi": _A_in["w_phi"],
        "A_wo": _A_in["wo"],
        "B_x": _B_in["x"],
        "B_w1": _B_in["w1"],
        "B_b1": _B_in["b1"],
        "B_w2": _B_in["w2"],
    }

def reference(A_x, A_wqkv, A_w_phi, A_wo, B_x, B_w1, B_b1, B_w2):
    def _A_ref(x, wqkv, w_phi, wo):
        B, S, D = x.shape
        H = 32; Dh = D // H
        qkv = (lambda x, *d: x.permute(*d))((x @ wqkv).reshape(B, S, 3, H, Dh), 2, 0, 3, 1, 4)
        q, k, v = qkv[0], qkv[1], qkv[2]
        pq = torch.einsum("bhsd,hdf->bhsf", q, w_phi)
        pk = torch.einsum("bhsd,hdf->bhsf", k, w_phi)
        phi_q = torch.concatenate([_softmax(pq, axis=-1), _softmax(-pq, axis=-1)], axis=-1)
        phi_k = torch.concatenate([_softmax(pk, axis=-1), _softmax(-pk, axis=-1)], axis=-1)
        kv = torch.einsum("bhsf,bhsd->bhfd", phi_k, v)
        z  = torch.einsum("bhsf->bhf", phi_k)
        num = torch.einsum("bhqf,bhfd->bhqd", phi_q, kv)
        den = torch.einsum("bhqf,bhf->bhq", phi_q, z)[..., None] + 1e-6
        o = num / den
        return (lambda x, *d: x.permute(*d))(o, 0, 2, 1, 3).reshape(B, S, D) @ wo

    def _B_ref(x, w1, b1, w2):
        h = torch.einsum("bsd,df->bsf", x, w1) + b1
        sp = torch.log1p(torch.exp(-torch.abs(h))) + torch.where(h > 0, h, torch.zeros_like(h))
        act = h * torch.tanh(sp)
        return torch.einsum("bsf,fd->bsd", act, w2)

    x = A_x
    xn = _layernorm(x, axis=-1)
    s = _A_ref(xn, A_wqkv, A_w_phi, A_wo)
    g = _silu(_B_ref(xn, B_w1, B_b1, B_w2))
    return x + s * g
```

```asm
; @launch grid=(256,1,1) block=(512,1,1) lds=163840
.amdgcn_target "amdgcn-amd-amdhsa--gfx950"
.text
.globl recurrent_scan__linear_kernel_hedgehog__dense_activation_mish__prompt_kernel
.p2align 8
.type recurrent_scan__linear_kernel_hedgehog__dense_activation_mish__prompt_kernel,@function
recurrent_scan__linear_kernel_hedgehog__dense_activation_mish__prompt_kernel:
    s_cmp_ge_u32 s2, 256
    s_cbranch_scc1 L_end
    s_load_dwordx8 s[4:11], s[0:1], 0
    s_load_dwordx8 s[12:19], s[0:1], 40
    s_load_dwordx4 s[20:23], s[0:1], 72
    v_lshrrev_b32 v1, 6, v0
    v_and_b32 v2, 63, v0
    s_and_b32 s76, s2, 7
    s_lshr_b32 s77, s2, 3
    v_readfirstlane_b32 s48, v1
    s_getpc_b64 s[70:71]
    v_lshlrev_b32 v33, 4, v2
    v_lshl_add_u32 v3, s77, 10, v33
    s_cmp_lg_u32 s48, 0
    s_cbranch_scc1 L_nopf
    global_load_dwordx4 v[16:19], v3, s[70:71]
L_nopf:
    s_and_b32 s78, s77, 3
    s_lshr_b32 s79, s77, 2
    s_and_b32 s51, s76, 3
    s_lshl_b32 s51, s51, 2
    s_add_u32 s51, s51, s78
    s_and_b32 s52, s76, 4
    s_and_b32 s72, s79, 3
    s_add_u32 s52, s52, s72
    s_lshl_b32 s53, s48, 11
    v_lshrrev_b32 v4, 3, v2
    v_lshl_add_u32 v4, v1, 4, v4
    v_and_b32 v5, 7, v2
    v_lshrrev_b32 v6, 4, v2
    v_xor_b32 v7, v5, v6
    v_lshlrev_b32 v7, 4, v7
    v_lshl_add_u32 v44, v4, 10, v7
    v_xor_b32 v45, 64, v44
    v_add_u32 v45, 7168, v45
    v_and_b32 v6, 1, v6
    v_lshlrev_b32 v6, 2, v6
    v_xor_b32 v7, v5, v6
    v_lshlrev_b32 v7, 4, v7
    v_mul_u32_u24 v46, 3072, v4
    v_add_u32 v46, v46, v7
    v_lshl_add_u32 v47, v4, 9, v46
    s_add_u32 s73, s78, s79
    s_lshl_b32 s74, s51, 17
    s_add_u32 s72, s73, 0
    s_and_b32 s72, s72, 3
    s_lshl_b32 s60, s72, 7
    s_lshl1_add_u32 s56, s60, s74
    s_add_u32 s72, s73, 1
    s_and_b32 s72, s72, 3
    s_lshl_b32 s61, s72, 7
    s_lshl1_add_u32 s57, s61, s74
    s_add_u32 s72, s73, 2
    s_and_b32 s72, s72, 3
    s_lshl_b32 s62, s72, 7
    s_lshl1_add_u32 s58, s62, s74
    s_add_u32 s72, s73, 3
    s_and_b32 s72, s72, 3
    s_lshl_b32 s63, s72, 7
    s_lshl1_add_u32 s59, s63, s74
    s_cmp_ge_u32 s77, 16
    s_cbranch_scc1 L_mlp
    s_mul_i32 s72, s52, 448
    s_and_b32 s70, s52, 1
    s_lshl_b32 s71, s70, 6
    s_add_u32 s71, s71, s72
    s_lshl_b32 s70, s52, 7
    s_add_u32 s64, s70, 1024
    s_add_u32 s65, s70, 2048
    s_add_u32 s66, s71, 256
    s_waitcnt lgkmcnt(0)
    s_mov_b32 s24, s4
    s_mov_b32 s25, s5
    s_mov_b32 s26, 0x200000
    s_mov_b32 s27, 0x20000
    s_mov_b32 s28, s6
    s_mov_b32 s29, s7
    s_mov_b32 s30, 0x180000
    s_mov_b32 s31, 0x20000
    s_or_b32 s70, s2, s48
    s_cbranch_scc1 L_np1
    s_memrealtime s[70:71]
    v_mov_b32 v8, 0
    s_waitcnt lgkmcnt(0)
    s_or_b32 s70, s70, 1
    v_mov_b32 v9, s70
    global_store_dword v8, v9, s[20:21] sc1
L_np1:
    s_add_u32 m0, s53, 0
    s_add_u32 s68, s56, 128
    buffer_load_dwordx4 v44, s[24:27], s56 offen lds
    buffer_load_dwordx4 v45, s[24:27], s56 offen offset:1024 lds
    s_add_u32 m0, s53, 16384
    s_nop 0
    buffer_load_dwordx4 v44, s[24:27], s68 offen lds
    buffer_load_dwordx4 v45, s[24:27], s68 offen offset:1024 lds
    s_add_u32 m0, s53, 49152
    s_add_u32 s68, s57, 128
    buffer_load_dwordx4 v44, s[24:27], s57 offen lds
    buffer_load_dwordx4 v45, s[24:27], s57 offen offset:1024 lds
    s_add_u32 m0, s53, 65536
    s_nop 0
    buffer_load_dwordx4 v44, s[24:27], s68 offen lds
    buffer_load_dwordx4 v45, s[24:27], s68 offen offset:1024 lds
    s_and_b32 s49, s48, 3
    s_lshr_b32 s50, s48, 2
    v_and_b32 v3, 31, v2
    v_lshrrev_b32 v4, 5, v2
    v_bfe_u32 v5, v2, 2, 2
    v_and_b32 v6, 3, v2
    v_bfe_u32 v7, v2, 4, 1
    s_lshl_b32 s70, s49, 5
    v_add_u32 v8, s70, v3
    v_bfe_u32 v9, v8, 1, 3
    v_xor_b32 v9, v9, v4
    v_lshlrev_b32 v9, 4, v9
    v_lshl_add_u32 v9, v8, 7, v9
    s_lshl_b32 s71, s50, 1
    s_xor_b32 s71, s71, s49
    s_and_b32 s72, s71, 1
    s_lshl_b32 s72, s72, 6
    s_lshr_b32 s73, s71, 1
    s_lshl_b32 s73, s73, 14
    s_or_b32 s72, s72, s73
    v_xor_b32 v80, s72, v9
    v_xor_b32 v81, 0x20, v80
    v_xor_b32 v82, 0x40, v80
    v_xor_b32 v83, 0x60, v80
    v_xor_b32 v84, 0x4000, v80
    v_xor_b32 v85, 0x4020, v80
    v_xor_b32 v86, 0x4040, v80
    v_xor_b32 v87, 0x4060, v80
    v_lshl_add_u32 v10, v4, 3, v5
    v_lshlrev_b32 v11, 5, v7
    v_lshl_add_u32 v11, v6, 3, v11
    v_lshrrev_b32 v12, 1, v5
    v_xor_b32 v12, s50, v12
    v_lshl_add_u32 v12, v12, 6, v11
    v_lshl_add_u32 v12, v10, 7, v12
    s_lshl_b32 s73, s71, 12
    v_add_u32 v48, s73, v12
    v_xor_b32 v49, 0x1000, v48
    v_xor_b32 v50, 0x2000, v48
    v_xor_b32 v51, 0x3000, v48
    v_bfe_u32 v13, v2, 2, 1
    v_xor_b32 v13, v13, v7
    v_add_u32 v13, -1, v13
    v_and_b32 v56, 0x3f803f80, v13
    v_mov_b32 v57, v56
    v_mov_b32 v58, v56
    v_mov_b32 v59, v56
    v_mov_b32 v52, 0x3f803f80
    v_mov_b32 v88, 0
    v_mov_b32 v89, 0
    v_mov_b32 v90, 0
    v_mov_b32 v91, 0
    v_mov_b32 v92, 0
    v_mov_b32 v93, 0
    v_mov_b32 v94, 0
    v_mov_b32 v95, 0
    s_mov_b32 s36, s12
    s_mov_b32 s37, s13
    s_mov_b32 s38, 0x1c0000
    s_mov_b32 s39, 0x20000
    s_mul_i32 s4, s60, 3584
    s_add_u32 s4, s4, s66
    s_mul_i32 s60, s60, 3072
    s_add_u32 s60, s60, s64
    s_mul_i32 s5, s61, 3584
    s_add_u32 s5, s5, s66
    s_mul_i32 s61, s61, 3072
    s_add_u32 s61, s61, s64
    s_mul_i32 s6, s62, 3584
    s_add_u32 s6, s6, s66
    s_mul_i32 s62, s62, 3072
    s_add_u32 s62, s62, s64
    s_mul_i32 s7, s63, 3584
    s_add_u32 s7, s7, s66
    s_mul_i32 s63, s63, 3072
    s_add_u32 s63, s63, s64
    s_lshl_b32 s54, s48, 10
    v_add_u32 v32, -1, v7
    s_lshl_b32 s73, s50, 9
    s_add_u32 s73, s73, 147456
    v_lshl_add_u32 v39, v3, 2, s73
    v_lshl_add_u32 v40, s49, 7, v39
    s_mul_i32 s73, s49, 147456
    s_lshl_b32 s72, s50, 11
    s_add_u32 s73, s73, s72
    v_add_u32 v42, s73, v33
    s_mul_i32 s55, s51, 589824
    v_lshlrev_b32 v54, 3, v8
    v_add_u32 v54, 148480, v54
    v_lshl_add_u32 v55, v4, 10, v54
    v_lshl_add_u32 v55, s50, 11, v55
    v_add_u32 v53, -1, v4
    v_lshlrev_b32 v41, 2, v8
    v_add_u32 v41, 152576, v41
    s_lshl_b32 s70, s52, 11
    v_lshl_add_u32 v13, v0, 2, s70
    s_lshl_b32 s69, s48, 8
    s_add_u32 s69, s69, 153600
    v_lshl_add_u32 v14, v4, 2, v5
    v_lshlrev_b32 v14, 5, v14
    v_lshl_add_u32 v14, v6, 3, v14
    v_lshl_add_u32 v14, v7, 9, v14
    s_lshl_b32 s70, s50, 10
    s_add_u32 s70, s70, 153600
    v_add_u32 v37, s70, v14
    s_lshl_b32 s71, s50, 11
    s_lshl_b32 s72, s49, 3
    s_add_u32 s72, s72, s71
    s_add_u32 s72, s72, 159744
    v_lshl_add_u32 v36, v3, 5, s72
    v_lshl_add_u32 v36, v4, 2, v36
    s_lshl_b32 s72, s49, 7
    s_add_u32 s72, s72, 152576
    v_lshl_add_u32 v38, v4, 4, s72
    v_add_u32 v12, 157696, v33
    v_bfe_u32 v8, v2, 2, 1
    v_xor_b32 v8, v8, v4
    v_add_u32 v8, -1, v8
    v_and_b32 v9, 1, v2
    v_lshlrev_b32 v9, 4, v9
    v_mov_b32 v10, 0x3f80
    v_lshlrev_b32 v9, v9, v10
    v_and_b32 v9, v9, v8
    v_bfe_u32 v10, v2, 3, 1
    v_bfe_u32 v11, v2, 1, 1
    v_lshl_add_u32 v10, v10, 1, v11
    v_cmp_eq_u32 vcc, 0, v10
    s_nop 1
    v_cndmask_b32 v28, 0, v9, vcc
    v_cmp_eq_u32 vcc, 1, v10
    s_nop 1
    v_cndmask_b32 v29, 0, v9, vcc
    v_cmp_eq_u32 vcc, 2, v10
    s_nop 1
    v_cndmask_b32 v30, 0, v9, vcc
    v_cmp_eq_u32 vcc, 3, v10
    s_nop 1
    v_cndmask_b32 v31, 0, v9, vcc
    v_and_b32 v24, v28, v32
    v_and_b32 v25, v29, v32
    v_and_b32 v26, v30, v32
    v_and_b32 v27, v31, v32
    v_xor_b32 v28, v28, v24
    v_xor_b32 v29, v29, v25
    v_xor_b32 v30, v30, v26
    v_xor_b32 v31, v31, v27
    ds_write_b128 v12, v[24:27]
    ds_write_b128 v12, v[28:31] offset:1024
    s_mov_b32 s32, s22
    s_mov_b32 s33, s23
    s_mov_b32 s34, 0xa20000
    s_mov_b32 s35, 0x20000
    s_mov_b32 s40, s16
    s_mov_b32 s41, s17
    s_mov_b32 s42, 0x1c0000
    s_mov_b32 s43, 0x20000
    s_mov_b32 s44, s10
    s_mov_b32 s45, s11
    s_mov_b32 s46, 0x80000
    s_mov_b32 s47, 0x20000
    s_and_b32 s12, s77, 3
    s_lshl_b32 s10, s76, 2
    s_add_u32 s10, s10, s12
    s_lshr_b32 s11, s77, 2
    s_mov_b32 s76, s18
    s_mov_b32 s77, s19
    s_mov_b32 s78, 0x200000
    s_mov_b32 s79, 0x20000
    s_lshl_b32 s12, s10, 1
    s_add_u32 s12, s12, s50
    s_mul_i32 s12, s12, 147456
    s_and_b32 s13, s48, 1
    s_lshl_b32 s13, s13, 11
    s_add_u32 s12, s12, s13
    s_bfe_u32 s13, s48, 0x10001
    s_mul_i32 s70, s13, 16384
    s_add_u32 s70, s70, s12
    s_mul_i32 s71, s13, 28672
    s_add_u32 s71, s71, s12
    s_mul_i32 s72, s13, 4096
    s_add_u32 s72, s72, s12
    s_lshl_b32 s12, s11, 7
    s_mul_i32 s73, s50, 262144
    s_add_u32 s73, s73, s12
    s_mul_i32 s74, s50, 458752
    s_add_u32 s74, s74, s12
    s_mul_i32 s75, s50, 65536
    s_add_u32 s75, s75, s12
    s_lshl3_add_u32 s80, s10, s48
    s_lshl_b32 s80, s80, 13
    s_add_u32 s80, s80, s12
    s_lshr_b32 s81, s10, 1
    s_lshl_b32 s81, s81, 11
    s_add_u32 s81, s81, 10551296
    s_lshl_b32 s17, s52, 7
    s_add_u32 s17, s17, 10551296
    s_lshl_b32 s16, s51, 11
    s_add_u32 s16, s16, s17
    s_add_u32 s72, s72, 114688
    s_lshl_b32 s10, s52, 13
    s_lshl_b32 s11, s51, 9
    s_add_u32 s10, s10, s11
    s_add_u32 s10, s10, 9437184
    v_add_u32 v8, s10, v33
    s_lshl_b32 s10, s52, 13
    s_and_b32 s11, s51, 7
    s_lshl_b32 s11, s11, 10
    s_add_u32 s10, s10, s11
    s_add_u32 s10, s10, 10485248
    v_add_u32 v9, s10, v33
    v_cmp_gt_u32 vcc, 32, v0
    s_nop 1
    v_cndmask_b32 v8, v9, v8, vcc
    v_cmp_gt_u32 vcc, 37, v0
    s_nop 1
    v_cndmask_b32 v8, -1, v8, vcc
    v_cmp_eq_u32 vcc, 36, v0
    s_waitcnt vmcnt(8)
    s_nop 0
    v_cndmask_b32 v16, 0, 1.0, vcc
    v_mov_b32 v17, v16
    v_mov_b32 v18, v16
    v_mov_b32 v19, v16
    buffer_store_dwordx4 v[16:19], v8, s[32:35], 0 offen sc1
    s_add_u32 m0, s53, 32768
    s_add_u32 s68, s60, 23552
    buffer_load_dwordx4 v46, s[28:31], s60 offen lds
    buffer_load_dwordx4 v46, s[28:31], s68 offen offset:1024 lds
    s_waitcnt vmcnt(3) lgkmcnt(0)
    s_barrier
    s_add_u32 m0, s53, 81920
    s_add_u32 s68, s61, 23552
    buffer_load_dwordx4 v46, s[28:31], s61 offen lds
    ds_read_b128 v[128:131], v80 offset:0
    ds_read_b128 v[132:135], v81 offset:0
    ds_read_b128 v[136:139], v82 offset:0
    ds_read_b128 v[140:143], v83 offset:0
    ds_read_b128 v[160:163], v80 offset:49152
    ds_read_b128 v[164:167], v81 offset:49152
    ds_read_b128 v[168:171], v82 offset:49152
    ds_read_b128 v[172:175], v83 offset:49152
    buffer_load_dwordx4 v46, s[28:31], s68 offen offset:1024 lds
    ds_read_b128 v[144:147], v84 offset:0
    ds_read_b128 v[148:151], v85 offset:0
    ds_read_b128 v[152:155], v86 offset:0
    ds_read_b128 v[156:159], v87 offset:0
    ds_read_b128 v[176:179], v84 offset:49152
    ds_read_b128 v[180:183], v85 offset:49152
    ds_read_b128 v[184:187], v86 offset:49152
    ds_read_b128 v[188:191], v87 offset:49152
    s_waitcnt lgkmcnt(15)
    v_dot2_f32_bf16 v88, v128, v52, v88
    v_dot2_f32_bf16 v89, v128, v128, v89
    v_dot2_f32_bf16 v90, v129, v52, v90
    v_dot2_f32_bf16 v91, v129, v129, v91
    v_dot2_f32_bf16 v92, v130, v52, v92
    v_dot2_f32_bf16 v93, v130, v130, v93
    v_dot2_f32_bf16 v94, v131, v52, v94
    v_dot2_f32_bf16 v95, v131, v131, v95
    s_waitcnt lgkmcnt(9)
    v_dot2_f32_bf16 v88, v132, v52, v88
    v_dot2_f32_bf16 v89, v132, v132, v89
    v_dot2_f32_bf16 v90, v133, v52, v90
    s_add_u32 m0, s53, 98304
    s_add_u32 s68, s58, 128
    buffer_load_dwordx4 v44, s[24:27], s58 offen lds
    v_dot2_f32_bf16 v91, v133, v133, v91
    v_dot2_f32_bf16 v92, v134, v52, v92
    v_dot2_f32_bf16 v93, v134, v134, v93
    v_dot2_f32_bf16 v94, v135, v52, v94
    v_dot2_f32_bf16 v95, v135, v135, v95
    v_dot2_f32_bf16 v88, v136, v52, v88
    v_dot2_f32_bf16 v89, v136, v136, v89
    v_dot2_f32_bf16 v90, v137, v52, v90
    v_dot2_f32_bf16 v91, v137, v137, v91
    v_dot2_f32_bf16 v92, v138, v52, v92
    buffer_load_dwordx4 v45, s[24:27], s58 offen offset:1024 lds
    v_dot2_f32_bf16 v93, v138, v138, v93
    v_dot2_f32_bf16 v94, v139, v52, v94
    v_dot2_f32_bf16 v95, v139, v139, v95
    v_dot2_f32_bf16 v88, v140, v52, v88
    v_dot2_f32_bf16 v89, v140, v140, v89
    v_dot2_f32_bf16 v90, v141, v52, v90
    v_dot2_f32_bf16 v91, v141, v141, v91
    v_dot2_f32_bf16 v92, v142, v52, v92
    v_dot2_f32_bf16 v93, v142, v142, v93
    v_dot2_f32_bf16 v94, v143, v52, v94
    v_dot2_f32_bf16 v95, v143, v143, v95
    s_add_u32 m0, s53, 114688
    s_nop 0
    buffer_load_dwordx4 v44, s[24:27], s68 offen lds
    v_dot2_f32_bf16 v88, v160, v52, v88
    v_dot2_f32_bf16 v89, v160, v160, v89
    v_dot2_f32_bf16 v90, v161, v52, v90
    v_dot2_f32_bf16 v91, v161, v161, v91
    v_dot2_f32_bf16 v92, v162, v52, v92
    v_dot2_f32_bf16 v93, v162, v162, v93
    v_dot2_f32_bf16 v94, v163, v52, v94
    v_dot2_f32_bf16 v95, v163, v163, v95
    v_dot2_f32_bf16 v88, v164, v52, v88
    v_dot2_f32_bf16 v89, v164, v164, v89
    v_dot2_f32_bf16 v90, v165, v52, v90
    buffer_load_dwordx4 v45, s[24:27], s68 offen offset:1024 lds
    v_dot2_f32_bf16 v91, v165, v165, v91
    v_dot2_f32_bf16 v92, v166, v52, v92
    v_dot2_f32_bf16 v93, v166, v166, v93
    v_dot2_f32_bf16 v94, v167, v52, v94
    v_dot2_f32_bf16 v95, v167, v167, v95
    v_dot2_f32_bf16 v88, v168, v52, v88
    v_dot2_f32_bf16 v89, v168, v168, v89
    v_dot2_f32_bf16 v90, v169, v52, v90
    v_dot2_f32_bf16 v91, v169, v169, v91
    v_dot2_f32_bf16 v92, v170, v52, v92
    s_add_u32 m0, s53, 131072
    s_add_u32 s68, s62, 23552
    buffer_load_dwordx4 v46, s[28:31], s62 offen lds
    v_dot2_f32_bf16 v93, v170, v170, v93
    v_dot2_f32_bf16 v94, v171, v52, v94
    v_dot2_f32_bf16 v95, v171, v171, v95
    s_waitcnt lgkmcnt(0)
    v_dot2_f32_bf16 v88, v172, v52, v88
    v_dot2_f32_bf16 v89, v172, v172, v89
    v_dot2_f32_bf16 v90, v173, v52, v90
    v_dot2_f32_bf16 v91, v173, v173, v91
    v_dot2_f32_bf16 v92, v174, v52, v92
    v_dot2_f32_bf16 v93, v174, v174, v93
    v_dot2_f32_bf16 v94, v175, v52, v94
    v_dot2_f32_bf16 v95, v175, v175, v95
    buffer_load_dwordx4 v46, s[28:31], s68 offen offset:1024 lds
    s_waitcnt vmcnt(8)
    s_barrier
    ds_read_b64_tr_b16 v[96:97], v48 offset:32768
    ds_read_b64_tr_b16 v[98:99], v48 offset:33280
    ds_read_b64_tr_b16 v[100:101], v48 offset:34816
    ds_read_b64_tr_b16 v[102:103], v48 offset:35328
    ds_read_b64_tr_b16 v[104:105], v49 offset:32768
    ds_read_b64_tr_b16 v[106:107], v49 offset:33280
    ds_read_b64_tr_b16 v[108:109], v49 offset:34816
    ds_read_b64_tr_b16 v[110:111], v49 offset:35328
    ds_read_b64_tr_b16 v[112:113], v50 offset:32768
    ds_read_b64_tr_b16 v[114:115], v50 offset:33280
    ds_read_b64_tr_b16 v[116:117], v50 offset:34816
    ds_read_b64_tr_b16 v[118:119], v50 offset:35328
    ds_read_b64_tr_b16 v[120:121], v51 offset:32768
    ds_read_b64_tr_b16 v[122:123], v51 offset:33280
    ds_read_b64_tr_b16 v[124:125], v51 offset:34816
    ds_read_b64_tr_b16 v[126:127], v51 offset:35328
    s_waitcnt lgkmcnt(14)
    v_mfma_f32_32x32x16_bf16 v[64:79], v[96:99], v[128:131], 0
    v_mfma_f32_16x16x32_bf16 v[60:63], v[56:59], v[96:99], 0
    s_add_u32 m0, s53, 0
    s_add_u32 s68, s59, 128
    buffer_load_dwordx4 v44, s[24:27], s59 offen lds
    s_waitcnt lgkmcnt(12)
    v_mfma_f32_32x32x16_bf16 v[64:79], v[100:103], v[132:135], v[64:79]
    v_mfma_f32_16x16x32_bf16 v[60:63], v[56:59], v[100:103], v[60:63]
    buffer_load_dwordx4 v45, s[24:27], s59 offen offset:1024 lds
    s_waitcnt lgkmcnt(9)
    v_mfma_f32_32x32x16_bf16 v[64:79], v[104:107], v[136:139], v[64:79]
    s_add_u32 m0, s53, 16384
    s_nop 0
    buffer_load_dwordx4 v44, s[24:27], s68 offen lds
    s_waitcnt lgkmcnt(4)
    v_mfma_f32_32x32x16_bf16 v[64:79], v[108:111], v[140:143], v[64:79]
    buffer_load_dwordx4 v45, s[24:27], s68 offen offset:1024 lds
    s_waitcnt vmcnt(10) lgkmcnt(0)
    s_barrier
    v_mfma_f32_32x32x16_bf16 v[64:79], v[112:115], v[144:147], v[64:79]
    v_mov_b32 v34, 0
    global_load_dword v34, v34, s[20:21] sc1
    v_add_u32 v48, 0x10000, v48
    v_add_u32 v49, 0x10000, v49
    v_add_u32 v50, 0x10000, v50
    v_add_u32 v51, 0x10000, v51
    ds_read_b64_tr_b16 v[96:97], v48 offset:16384
    ds_read_b64_tr_b16 v[98:99], v48 offset:16896
    s_add_u32 m0, s53, 49152
    s_add_u32 s68, s63, 23552
    buffer_load_dwordx4 v46, s[28:31], s63 offen lds
    v_mfma_f32_32x32x16_bf16 v[64:79], v[116:119], v[148:151], v[64:79]
    ds_read_b64_tr_b16 v[100:101], v48 offset:18432
    ds_read_b64_tr_b16 v[102:103], v48 offset:18944
    ds_read_b64_tr_b16 v[104:105], v49 offset:16384
    ds_read_b64_tr_b16 v[106:107], v49 offset:16896
    v_lshrrev_b32 v45, 2, v33
    v_and_b32 v45, 64, v45
    v_mfma_f32_32x32x16_bf16 v[64:79], v[120:123], v[152:155], v[64:79]
    ds_read_b64_tr_b16 v[108:109], v49 offset:18432
    ds_read_b64_tr_b16 v[110:111], v49 offset:18944
    buffer_load_dwordx4 v46, s[28:31], s68 offen offset:1024 lds
    v_and_b32 v44, 0x70, v33
    v_mfma_f32_32x32x16_bf16 v[64:79], v[124:127], v[156:159], v[64:79]
    ds_read_b64_tr_b16 v[112:113], v50 offset:16384
    ds_read_b64_tr_b16 v[114:115], v50 offset:16896
    ds_read_b64_tr_b16 v[116:117], v50 offset:18432
    ds_read_b64_tr_b16 v[118:119], v50 offset:18944
    v_xor_b32 v44, v44, v45
    v_lshrrev_b32 v45, 7, v33
    s_waitcnt lgkmcnt(10)
    v_mfma_f32_32x32x16_bf16 v[64:79], v[96:99], v[160:163], v[64:79]
    ds_read_b64_tr_b16 v[120:121], v51 offset:16384
    ds_read_b64_tr_b16 v[122:123], v51 offset:16896
    v_mfma_f32_16x16x32_bf16 v[60:63], v[56:59], v[96:99], v[60:63]
    s_add_u32 m0, s53, 65536
    s_add_u32 s68, s60, 1024
    buffer_load_dwordx4 v46, s[28:31], s68 offen lds
    s_waitcnt lgkmcnt(8)
    v_mfma_f32_32x32x16_bf16 v[64:79], v[100:103], v[164:167], v[64:79]
    ds_read_b64_tr_b16 v[124:125], v51 offset:18432
    ds_read_b64_tr_b16 v[126:127], v51 offset:18944
    v_mfma_f32_16x16x32_bf16 v[60:63], v[56:59], v[100:103], v[60:63]
    v_mfma_f32_32x32x16_bf16 v[64:79], v[104:107], v[168:171], v[64:79]
    s_add_u32 s68, s68, 23552
    buffer_load_dwordx4 v46, s[28:31], s68 offen offset:1024 lds
    v_lshl_add_u32 v44, v45, 10, v44
    s_lshl_b32 s12, s49, 14
    s_waitcnt lgkmcnt(4)
    v_mfma_f32_32x32x16_bf16 v[64:79], v[108:111], v[172:175], v[64:79]
    v_add_u32 v44, s12, v44
    v_add_u32 v45, 7168, v44
    s_waitcnt vmcnt(9) lgkmcnt(0)
    s_barrier
    v_mfma_f32_32x32x16_bf16 v[64:79], v[112:115], v[176:179], v[64:79]
    s_mov_b32 m0, s69
    s_nop 0
    global_load_lds_dword v13, s[8:9]
    v_add_u32 v48, 0x8000, v48
    v_add_u32 v49, 0x8000, v49
    v_add_u32 v50, 0x8000, v50
    v_add_u32 v51, 0x8000, v51
    v_add_u32 v80, 0x10000, v80
    v_add_u32 v81, 0x10000, v81
    v_add_u32 v82, 0x10000, v82
    v_add_u32 v83, 0x10000, v83
    v_add_u32 v84, 0x10000, v84
    v_add_u32 v85, 0x10000, v85
    v_add_u32 v86, 0x10000, v86
    v_add_u32 v87, 0x10000, v87
    ds_read_b64_tr_b16 v[96:97], v48 offset:32768
    ds_read_b64_tr_b16 v[98:99], v48 offset:33280
    ds_read_b128 v[192:195], v80 offset:32768
    ds_read_b64_tr_b16 v[100:101], v48 offset:34816
    ds_read_b64_tr_b16 v[102:103], v48 offset:35328
    ds_read_b128 v[196:199], v81 offset:32768
    s_add_u32 m0, s53, 32768
    s_add_u32 s68, s61, 1024
    buffer_load_dwordx4 v46, s[28:31], s68 offen lds
    v_mfma_f32_32x32x16_bf16 v[64:79], v[116:119], v[180:183], v[64:79]
    ds_read_b64_tr_b16 v[104:105], v49 offset:32768
    ds_read_b64_tr_b16 v[106:107], v49 offset:33280
    ds_read_b128 v[200:203], v82 offset:32768
    ds_read_b64_tr_b16 v[108:109], v49 offset:34816
    ds_read_b64_tr_b16 v[110:111], v49 offset:35328
    ds_read_b128 v[204:207], v83 offset:32768
    s_add_u32 s68, s68, 23552
    buffer_load_dwordx4 v46, s[28:31], s68 offen offset:1024 lds
    v_mfma_f32_32x32x16_bf16 v[64:79], v[120:123], v[184:187], v[64:79]
    ds_read_b64_tr_b16 v[112:113], v50 offset:32768
    ds_read_b64_tr_b16 v[114:115], v50 offset:33280
    ds_read_b128 v[208:211], v84 offset:32768
    ds_read_b64_tr_b16 v[116:117], v50 offset:34816
    ds_read_b64_tr_b16 v[118:119], v50 offset:35328
    ds_read_b128 v[212:215], v85 offset:32768
    v_mfma_f32_32x32x16_bf16 v[64:79], v[124:127], v[188:191], v[64:79]
    ds_read_b64_tr_b16 v[120:121], v51 offset:32768
    ds_read_b64_tr_b16 v[122:123], v51 offset:33280
    ds_read_b128 v[216:219], v86 offset:32768
    s_add_u32 m0, s53, 81920
    s_add_u32 s68, s62, 1024
    buffer_load_dwordx4 v46, s[28:31], s68 offen lds
    s_waitcnt lgkmcnt(12)
    v_dot2_f32_bf16 v88, v192, v52, v88
    v_dot2_f32_bf16 v89, v192, v192, v89
    v_dot2_f32_bf16 v90, v193, v52, v90
    v_dot2_f32_bf16 v91, v193, v193, v91
    v_dot2_f32_bf16 v92, v194, v52, v92
    v_dot2_f32_bf16 v93, v194, v194, v93
    v_dot2_f32_bf16 v94, v195, v52, v94
    v_dot2_f32_bf16 v95, v195, v195, v95
    v_dot2_f32_bf16 v88, v196, v52, v88
    v_dot2_f32_bf16 v89, v196, v196, v89
    v_dot2_f32_bf16 v90, v197, v52, v90
    v_dot2_f32_bf16 v91, v197, v197, v91
    v_dot2_f32_bf16 v92, v198, v52, v92
    v_dot2_f32_bf16 v93, v198, v198, v93
    v_dot2_f32_bf16 v94, v199, v52, v94
    v_dot2_f32_bf16 v95, v199, v199, v95
    v_dot2_f32_bf16 v88, v200, v52, v88
    v_dot2_f32_bf16 v89, v200, v200, v89
    v_dot2_f32_bf16 v90, v201, v52, v90
    v_dot2_f32_bf16 v91, v201, v201, v91
    v_dot2_f32_bf16 v92, v202, v52, v92
    v_dot2_f32_bf16 v93, v202, v202, v93
    v_dot2_f32_bf16 v94, v203, v52, v94
    v_dot2_f32_bf16 v95, v203, v203, v95
    s_waitcnt lgkmcnt(0)
    v_dot2_f32_bf16 v88, v204, v52, v88
    v_dot2_f32_bf16 v89, v204, v204, v89
    v_dot2_f32_bf16 v90, v205, v52, v90
    v_dot2_f32_bf16 v91, v205, v205, v91
    v_dot2_f32_bf16 v92, v206, v52, v92
    v_dot2_f32_bf16 v93, v206, v206, v93
    v_dot2_f32_bf16 v94, v207, v52, v94
    v_dot2_f32_bf16 v95, v207, v207, v95
    v_mfma_f32_32x32x16_bf16 v[64:79], v[96:99], v[192:195], v[64:79]
    ds_read_b64_tr_b16 v[124:125], v51 offset:34816
    ds_read_b64_tr_b16 v[126:127], v51 offset:35328
    ds_read_b128 v[220:223], v87 offset:32768
    v_mfma_f32_16x16x32_bf16 v[60:63], v[56:59], v[96:99], v[60:63]
    s_add_u32 s68, s68, 23552
    buffer_load_dwordx4 v46, s[28:31], s68 offen offset:1024 lds
    v_mfma_f32_32x32x16_bf16 v[64:79], v[100:103], v[196:199], v[64:79]
    v_mfma_f32_16x16x32_bf16 v[60:63], v[56:59], v[100:103], v[60:63]
    v_mfma_f32_32x32x16_bf16 v[64:79], v[104:107], v[200:203], v[64:79]
    v_bfe_u32 v35, v33, 3, 6
    v_add_u32 v35, s66, v35
    v_lshl_add_u32 v35, s50, 6, v35
    global_load_ushort v35, v35, s[14:15]
    v_mfma_f32_32x32x16_bf16 v[64:79], v[108:111], v[204:207], v[64:79]
    s_waitcnt vmcnt(8) lgkmcnt(0)
    s_barrier
    v_mfma_f32_32x32x16_bf16 v[64:79], v[112:115], v[208:211], v[64:79]
    v_add_u32 v48, 0xfffe8000, v48
    v_add_u32 v49, 0xfffe8000, v49
    v_add_u32 v50, 0xfffe8000, v50
    v_add_u32 v51, 0xfffe8000, v51
    v_add_u32 v80, 0xffff0000, v80
    v_add_u32 v81, 0xffff0000, v81
    v_add_u32 v82, 0xffff0000, v82
    v_add_u32 v83, 0xffff0000, v83
    v_add_u32 v84, 0xffff0000, v84
    v_add_u32 v85, 0xffff0000, v85
    v_add_u32 v86, 0xffff0000, v86
    v_add_u32 v87, 0xffff0000, v87
    ds_read_b64_tr_b16 v[96:97], v48 offset:49152
    ds_read_b64_tr_b16 v[98:99], v48 offset:49664
    ds_read_b128 v[224:227], v80 offset:0
    ds_read_b64_tr_b16 v[100:101], v48 offset:51200
    ds_read_b64_tr_b16 v[102:103], v48 offset:51712
    ds_read_b128 v[228:231], v81 offset:0
    s_add_u32 m0, s53, 98304
    s_add_u32 s68, s63, 1024
    buffer_load_dwordx4 v46, s[28:31], s68 offen lds
    v_mfma_f32_32x32x16_bf16 v[64:79], v[116:119], v[212:215], v[64:79]
    ds_read_b64_tr_b16 v[104:105], v49 offset:49152
    ds_read_b64_tr_b16 v[106:107], v49 offset:49664
    ds_read_b128 v[232:235], v82 offset:0
    ds_read_b64_tr_b16 v[108:109], v49 offset:51200
    ds_read_b64_tr_b16 v[110:111], v49 offset:51712
    ds_read_b128 v[236:239], v83 offset:0
    s_add_u32 s68, s68, 23552
    buffer_load_dwordx4 v46, s[28:31], s68 offen offset:1024 lds
    v_mfma_f32_32x32x16_bf16 v[64:79], v[120:123], v[216:219], v[64:79]
    ds_read_b64_tr_b16 v[112:113], v50 offset:49152
    ds_read_b64_tr_b16 v[114:115], v50 offset:49664
    ds_read_b128 v[240:243], v84 offset:0
    ds_read_b64_tr_b16 v[116:117], v50 offset:51200
    ds_read_b64_tr_b16 v[118:119], v50 offset:51712
    ds_read_b128 v[244:247], v85 offset:0
    s_add_u32 m0, s53, 114688
    s_add_u32 s68, s4, 27648
    buffer_load_dwordx4 v47, s[36:39], s4 offen lds
    v_mfma_f32_32x32x16_bf16 v[64:79], v[124:127], v[220:223], v[64:79]
    ds_read_b64_tr_b16 v[120:121], v51 offset:49152
    ds_read_b64_tr_b16 v[122:123], v51 offset:49664
    ds_read_b128 v[248:251], v86 offset:0
    s_waitcnt lgkmcnt(12)
    v_dot2_f32_bf16 v88, v224, v52, v88
    v_dot2_f32_bf16 v89, v224, v224, v89
    v_dot2_f32_bf16 v90, v225, v52, v90
    v_dot2_f32_bf16 v91, v225, v225, v91
    v_dot2_f32_bf16 v92, v226, v52, v92
    v_dot2_f32_bf16 v93, v226, v226, v93
    v_dot2_f32_bf16 v94, v227, v52, v94
    v_dot2_f32_bf16 v95, v227, v227, v95
    v_dot2_f32_bf16 v88, v228, v52, v88
    v_dot2_f32_bf16 v89, v228, v228, v89
    v_dot2_f32_bf16 v90, v229, v52, v90
    v_dot2_f32_bf16 v91, v229, v229, v91
    v_dot2_f32_bf16 v92, v230, v52, v92
    v_dot2_f32_bf16 v93, v230, v230, v93
    v_dot2_f32_bf16 v94, v231, v52, v94
    v_dot2_f32_bf16 v95, v231, v231, v95
    v_dot2_f32_bf16 v88, v232, v52, v88
    v_dot2_f32_bf16 v89, v232, v232, v89
    v_dot2_f32_bf16 v90, v233, v52, v90
    v_dot2_f32_bf16 v91, v233, v233, v91
    v_dot2_f32_bf16 v92, v234, v52, v92
    v_dot2_f32_bf16 v93, v234, v234, v93
    v_dot2_f32_bf16 v94, v235, v52, v94
    v_dot2_f32_bf16 v95, v235, v235, v95
    s_waitcnt lgkmcnt(0)
    v_dot2_f32_bf16 v88, v236, v52, v88
    v_dot2_f32_bf16 v89, v236, v236, v89
    v_dot2_f32_bf16 v90, v237, v52, v90
    v_dot2_f32_bf16 v91, v237, v237, v91
    v_dot2_f32_bf16 v92, v238, v52, v92
    v_dot2_f32_bf16 v93, v238, v238, v93
    v_dot2_f32_bf16 v94, v239, v52, v94
    v_dot2_f32_bf16 v95, v239, v239, v95
    v_add_f32 v88, v88, v92
    v_add_f32 v89, v89, v93
    v_add_f32 v90, v90, v94
    v_add_f32 v91, v91, v95
    v_add_f32 v88, v88, v90
    v_add_f32 v89, v89, v91
    ds_write_b64 v55, v[88:89]
    v_mfma_f32_32x32x16_bf16 v[64:79], v[96:99], v[224:227], v[64:79]
    ds_read_b64_tr_b16 v[124:125], v51 offset:51200
    ds_read_b64_tr_b16 v[126:127], v51 offset:51712
    ds_read_b128 v[252:255], v87 offset:0
    v_mfma_f32_16x16x32_bf16 v[60:63], v[56:59], v[96:99], v[60:63]
    buffer_load_dwordx4 v47, s[36:39], s68 offen offset:1024 lds
    v_mfma_f32_32x32x16_bf16 v[64:79], v[100:103], v[228:231], v[64:79]
    v_mfma_f32_16x16x32_bf16 v[60:63], v[56:59], v[100:103], v[60:63]
    s_add_u32 m0, s53, 131072
    s_add_u32 s68, s5, 27648
    buffer_load_dwordx4 v47, s[36:39], s5 offen lds
    v_mfma_f32_32x32x16_bf16 v[64:79], v[104:107], v[232:235], v[64:79]
    buffer_load_dwordx4 v47, s[36:39], s68 offen offset:1024 lds
    v_mfma_f32_32x32x16_bf16 v[64:79], v[108:111], v[236:239], v[64:79]
    s_nop 1
    ds_write_b32 v40, v60
    s_cmp_lg_u32 s48, 0
    s_cbranch_scc1 L_po8
    s_mov_b32 s11, 0
L_pc7:
    v_readfirstlane_b32 s3, v34
    s_nop 2
    s_cmp_lg_u32 s3, 0
    s_cbranch_scc1 L_po8
    s_add_u32 s11, s11, 1
    s_cmp_ge_u32 s11, 0x40000
    s_cbranch_scc1 L_po8
    s_sleep 1
    v_mov_b32 v34, 0
    global_load_dword v34, v34, s[20:21] sc1
    s_waitcnt vmcnt(0)
    s_branch L_pc7
L_po8:
    s_waitcnt vmcnt(11) lgkmcnt(0)
    s_barrier
    v_mfma_f32_32x32x16_bf16 v[64:79], v[112:115], v[240:243], v[64:79]
    s_cmp_lg_u32 s48, 0
    s_cbranch_scc1 L_w03
    v_mov_b32 v61, s3
    buffer_store_dword v61, off, s[32:35], s16 offset:4 sc1
L_w03:
    ds_read2st64_b64 v[16:19], v54 offset0:0 offset1:2
    ds_read2st64_b64 v[20:23], v54 offset0:4 offset1:6
    ds_read2_b32 v[8:9], v39 offset0:0 offset1:32
    ds_read2_b32 v[10:11], v39 offset0:64 offset1:96
    v_add_u32 v48, 0x10000, v48
    v_add_u32 v49, 0x10000, v49
    v_add_u32 v50, 0x10000, v50
    v_add_u32 v51, 0x10000, v51
    ds_read_b64_tr_b16 v[96:97], v48 offset:0
    ds_read_b64_tr_b16 v[98:99], v48 offset:512
    s_add_u32 m0, s53, 0
    s_add_u32 s68, s6, 27648
    buffer_load_dwordx4 v47, s[36:39], s6 offen lds
    v_mfma_f32_32x32x16_bf16 v[64:79], v[116:119], v[244:247], v[64:79]
    ds_read_b64_tr_b16 v[100:101], v48 offset:2048
    ds_read_b64_tr_b16 v[102:103], v48 offset:2560
    ds_read_b64_tr_b16 v[104:105], v49 offset:0
    ds_read_b64_tr_b16 v[106:107], v49 offset:512
    s_waitcnt lgkmcnt(9)
    v_add_f32 v16, v16, v18
    v_add_f32 v17, v17, v19
    s_waitcnt lgkmcnt(8)
    v_add_f32 v20, v20, v22
    v_add_f32 v21, v21, v23
    v_add_f32 v16, v16, v20
    v_add_f32 v17, v17, v21
    v_mul_f32 v16, 0xbb000000, v16
    v_mul_f32 v18, v16, v16
    v_mul_f32 v17, 0x3b000000, v17
    v_sub_f32 v17, v17, v18
    v_max_f32 v17, 0, v17
    v_add_f32 v17, 0x3727c5ac, v17
    v_mfma_f32_32x32x16_bf16 v[64:79], v[120:123], v[248:251], v[64:79]
    ds_read_b64_tr_b16 v[108:109], v49 offset:2048
    ds_read_b64_tr_b16 v[110:111], v49 offset:2560
    v_rsq_f32 v18, v17
    v_cvt_pk_bf16_f32 v20, v16, v16
    v_mul_f32 v19, v17, v18
    ds_write_b32 v41, v18
    v_and_b32 v21, 0xffff0000, v20
    v_sub_f32 v21, v16, v21
    v_cvt_pk_bf16_f32 v22, v21, v19
    v_and_b32 v23, 0xffff0000, v22
    v_sub_f32 v23, v19, v23
    v_cvt_pk_bf16_f32 v23, v23, 0
    v_mul_f32 v41, 0x3fb8aa3b, v18
    v_and_b32 v52, v20, v53
    buffer_load_dwordx4 v47, s[36:39], s68 offen offset:1024 lds
    v_mfma_f32_32x32x16_bf16 v[64:79], v[124:127], v[252:255], v[64:79]
    ds_read_b64_tr_b16 v[112:113], v50 offset:0
    ds_read_b64_tr_b16 v[114:115], v50 offset:512
    ds_read_b64_tr_b16 v[116:117], v50 offset:2048
    ds_read_b64_tr_b16 v[118:119], v50 offset:2560
    v_and_b32 v54, v23, v53
    v_and_b32 v53, v22, v53
    v_mov_b32 v55, 0
    v_mov_b32 v2, 0
    v_mov_b32 v3, 0
    s_waitcnt lgkmcnt(4)
    v_add_f32 v8, v8, v9
    v_add_f32 v10, v10, v11
    v_add_f32 v8, v8, v10
    v_cvt_pk_bf16_f32 v9, v8, v8
    v_cvt_pk_bf16_f32 v1, v8, 0
    v_and_b32 v9, 0xffff0000, v9
    v_sub_f32 v9, v8, v9
    v_cvt_pk_bf16_f32 v0, v8, v9
    s_nop 1
    v_mfma_f32_32x32x16_bf16 v[64:79], v[0:3], v[52:55], v[64:79]
    s_add_u32 m0, s53, 16384
    s_add_u32 s68, s7, 27648
    buffer_load_dwordx4 v47, s[36:39], s7 offen lds
    v_mfma_f32_32x32x16_bf16 v[80:95], v[128:131], v[96:99], 0
    ds_read_b64_tr_b16 v[120:121], v51 offset:0
    ds_read_b64_tr_b16 v[122:123], v51 offset:512
    v_mfma_f32_16x16x32_bf16 v[60:63], v[56:59], v[96:99], 0
    v_mfma_f32_32x32x16_bf16 v[80:95], v[132:135], v[100:103], v[80:95]
    ds_read_b64_tr_b16 v[124:125], v51 offset:2048
    ds_read_b64_tr_b16 v[126:127], v51 offset:2560
    v_mfma_f32_16x16x32_bf16 v[60:63], v[56:59], v[100:103], v[60:63]
    buffer_load_dwordx4 v47, s[36:39], s68 offen offset:1024 lds
    ds_read_b64_tr_b16 v[4:5], v37
    ds_read_b64_tr_b16 v[6:7], v37 offset:256
    v_bfe_u32 v8, v33, 8, 1
    v_add_u32 v8, -1, v8
    v_cvt_pk_bf16_f32 v20, v72, v73
    v_mfma_f32_32x32x16_bf16 v[80:95], v[136:139], v[104:107], v[80:95]
    v_cvt_pk_bf16_f32 v21, v74, v75
    v_cvt_pk_bf16_f32 v22, v76, v77
    v_cvt_pk_bf16_f32 v23, v78, v79
    v_cvt_pk_bf16_f32 v16, v64, v65
    v_cvt_pk_bf16_f32 v17, v66, v67
    v_cvt_pk_bf16_f32 v18, v68, v69
    v_cvt_pk_bf16_f32 v19, v70, v71
    s_waitcnt lgkmcnt(1)
    v_and_b32 v0, v4, v8
    v_and_b32 v1, v5, v8
    s_waitcnt lgkmcnt(0)
    v_and_b32 v2, v6, v8
    v_and_b32 v3, v7, v8
    v_xor_b32 v4, v4, v0
    v_xor_b32 v5, v5, v1
    v_mfma_f32_32x32x16_bf16 v[80:95], v[140:143], v[108:111], v[80:95]
    v_xor_b32 v6, v6, v2
    v_xor_b32 v7, v7, v3
    s_nop 1
    v_mfma_f32_32x32x16_bf16 v[64:79], v[4:7], v[20:23], 0
    s_waitcnt vmcnt(13)
    s_barrier
    v_mfma_f32_32x32x16_bf16 v[80:95], v[144:147], v[112:115], v[80:95]
    v_and_b32 v34, 0xf0, v33
    v_lshlrev_b32 v34, 7, v34
    buffer_load_dword v34, v34, s[32:35], s17 offen offset:4 sc1
    s_sub_u32 s10, s48, 0
    s_and_b32 s10, s10, 7
    s_mov_b32 m0, 153344
    s_bfe_u32 s11, s2, 0x50003
    s_mul_i32 s11, s11, 7
    s_add_u32 s11, s10, s11
    s_add_u32 s11, s11, 0
    s_lshl_b32 s11, s11, 13
    s_cmp_ge_u32 s10, 7
    s_cselect_b32 s11, 0x80000000, s11
    v_lshl_add_u32 v61, v33, 3, s11
    buffer_load_dword v61, s[40:43], 0 offen lds
    v_add_u32 v48, 0xffff0000, v48
    v_add_u32 v49, 0xffff0000, v49
    v_add_u32 v50, 0xffff0000, v50
    v_add_u32 v51, 0xffff0000, v51
    ds_read_b64_tr_b16 v[96:97], v48 offset:32768
    ds_read_b64_tr_b16 v[98:99], v48 offset:33280
    v_mfma_f32_32x32x16_bf16 v[80:95], v[148:151], v[116:119], v[80:95]
    ds_read_b64_tr_b16 v[100:101], v48 offset:34816
    ds_read_b64_tr_b16 v[102:103], v48 offset:35328
    ds_read_b64_tr_b16 v[104:105], v49 offset:32768
    ds_read_b64_tr_b16 v[106:107], v49 offset:33280
    v_mfma_f32_32x32x16_bf16 v[64:79], v[0:3], v[16:19], v[64:79]
    v_mfma_f32_32x32x16_bf16 v[80:95], v[152:155], v[120:123], v[80:95]
    ds_read_b64_tr_b16 v[108:109], v49 offset:34816
    ds_read_b64_tr_b16 v[110:111], v49 offset:35328
    s_nop 8
    v_max3_f32 v8, v64, v65, v66
    v_max3_f32 v9, -v64, -v65, -v66
    v_max3_f32 v8, v8, v67, v68
    v_max3_f32 v9, v9, -v67, -v68
    v_max3_f32 v8, v8, v69, v70
    v_max3_f32 v9, v9, -v69, -v70
    v_max_f32 v8, v8, v71
    v_max_f32_e64 v9, v9, -v71
    v_mfma_f32_32x32x16_bf16 v[80:95], v[156:159], v[124:127], v[80:95]
    ds_read_b64_tr_b16 v[112:113], v50 offset:32768
    ds_read_b64_tr_b16 v[114:115], v50 offset:33280
    ds_read_b64_tr_b16 v[116:117], v50 offset:34816
    ds_read_b64_tr_b16 v[118:119], v50 offset:35328
    v_max3_f32 v10, v72, v73, v74
    v_max3_f32 v11, -v72, -v73, -v74
    v_max3_f32 v10, v10, v75, v76
    v_max3_f32 v11, v11, -v75, -v76
    v_max3_f32 v10, v10, v77, v78
    v_max3_f32 v11, v11, -v77, -v78
    v_max_f32 v10, v10, v79
    v_max_f32_e64 v11, v11, -v79
    v_permlane32_swap_b32 v8, v9
    s_nop 0
    v_permlane32_swap_b32 v10, v11
    s_waitcnt lgkmcnt(4)
    v_mfma_f32_32x32x16_bf16 v[80:95], v[160:163], v[96:99], v[80:95]
    ds_read_b64_tr_b16 v[120:121], v51 offset:32768
    ds_read_b64_tr_b16 v[122:123], v51 offset:33280
    v_mfma_f32_16x16x32_bf16 v[60:63], v[56:59], v[96:99], v[60:63]
    v_max_f32 v8, v8, v9
    v_max_f32 v10, v10, v11
    v_mov_b32 v9, v8
    v_mov_b32 v11, v10
    s_nop 0
    v_permlane32_swap_b32 v8, v9
    v_permlane32_swap_b32 v10, v11
    v_mul_f32_e64 v8, -v8, v41
    v_mfma_f32_32x32x16_bf16 v[80:95], v[164:167], v[100:103], v[80:95]
    ds_read_b64_tr_b16 v[124:125], v51 offset:34816
    ds_read_b64_tr_b16 v[126:127], v51 offset:35328
    v_mfma_f32_16x16x32_bf16 v[60:63], v[56:59], v[100:103], v[60:63]
    v_mul_f32_e64 v9, -v9, v41
    v_mul_f32_e64 v10, -v10, v41
    v_mul_f32_e64 v11, -v11, v41
    v_fma_f32 v24, v64, v41, v8
    v_fma_f32 v25, v65, v41, v8
    v_fma_f32 v26, v66, v41, v8
    v_fma_f32 v27, v67, v41, v8
    v_fma_f32 v28, v68, v41, v8
    v_fma_f32 v29, v69, v41, v8
    v_mfma_f32_32x32x16_bf16 v[80:95], v[168:171], v[104:107], v[80:95]
    v_fma_f32 v30, v70, v41, v8
    v_fma_f32 v31, v71, v41, v8
    v_fma_f32 v64, -v64, v41, v9
    v_fma_f32 v65, -v65, v41, v9
    v_fma_f32 v66, -v66, v41, v9
    v_fma_f32 v67, -v67, v41, v9
    v_fma_f32 v68, -v68, v41, v9
    v_fma_f32 v69, -v69, v41, v9
    v_fma_f32 v70, -v70, v41, v9
    v_fma_f32 v71, -v71, v41, v9
    v_exp_f32 v24, v24
    v_exp_f32 v25, v25
    v_mfma_f32_32x32x16_bf16 v[80:95], v[172:175], v[108:111], v[80:95]
    v_exp_f32 v26, v26
    v_exp_f32 v27, v27
    v_exp_f32 v28, v28
    v_exp_f32 v29, v29
    v_exp_f32 v30, v30
    v_exp_f32 v31, v31
    s_waitcnt vmcnt(13) lgkmcnt(0)
    s_barrier
    v_mfma_f32_32x32x16_bf16 v[80:95], v[176:179], v[112:115], v[80:95]
    s_sub_u32 s10, s48, 7
    s_and_b32 s10, s10, 7
    s_mov_b32 m0, 153344
    s_bfe_u32 s11, s2, 0x50003
    s_mul_i32 s11, s11, 2
    s_add_u32 s11, s10, s11
    s_add_u32 s11, s11, 0
    s_lshl_b32 s11, s11, 13
    s_cmp_ge_u32 s10, 2
    s_cselect_b32 s11, 0x80000000, s11
    v_lshl_add_u32 v61, v33, 3, s11
    buffer_load_dword v61, s[44:47], 0 offen lds
    v_add_u32 v48, 0x10000, v48
    v_add_u32 v49, 0x10000, v49
    v_add_u32 v50, 0x10000, v50
    v_add_u32 v51, 0x10000, v51
    ds_read_b64_tr_b16 v[96:97], v48 offset:16384
    ds_read_b64_tr_b16 v[98:99], v48 offset:16896
    v_mfma_f32_32x32x16_bf16 v[80:95], v[180:183], v[116:119], v[80:95]
    ds_read_b64_tr_b16 v[100:101], v48 offset:18432
    ds_read_b64_tr_b16 v[102:103], v48 offset:18944
    ds_read_b64_tr_b16 v[104:105], v49 offset:16384
    ds_read_b64_tr_b16 v[106:107], v49 offset:16896
    v_exp_f32 v64, v64
    v_exp_f32 v65, v65
    v_exp_f32 v66, v66
    v_exp_f32 v67, v67
    v_exp_f32 v68, v68
    v_exp_f32 v69, v69
    v_mfma_f32_32x32x16_bf16 v[80:95], v[184:187], v[120:123], v[80:95]
    ds_read_b64_tr_b16 v[108:109], v49 offset:18432
    ds_read_b64_tr_b16 v[110:111], v49 offset:18944
    v_exp_f32 v70, v70
    v_exp_f32 v71, v71
    v_add_f32 v12, v24, v25
    v_add_f32 v14, v26, v27
    v_add_f32 v13, v64, v65
    v_add_f32 v15, v66, v67
    v_add_f32 v12, v12, v28
    v_add_f32 v14, v14, v29
    v_add_f32 v13, v13, v68
    v_add_f32 v15, v15, v69
    v_mfma_f32_32x32x16_bf16 v[80:95], v[188:191], v[124:127], v[80:95]
    ds_read_b64_tr_b16 v[112:113], v50 offset:16384
    ds_read_b64_tr_b16 v[114:115], v50 offset:16896
    ds_read_b64_tr_b16 v[116:117], v50 offset:18432
    ds_read_b64_tr_b16 v[118:119], v50 offset:18944
    v_add_f32 v12, v12, v30
    v_add_f32 v14, v14, v31
    v_add_f32 v13, v13, v70
    v_add_f32 v15, v15, v71
    v_add_f32 v12, v12, v14
    v_add_f32 v13, v13, v15
    s_nop 1
    v_permlane32_swap_b32 v12, v13
    v_add_f32 v12, v12, v13
    v_rcp_f32 v12, v12
    s_waitcnt lgkmcnt(4)
    v_mfma_f32_32x32x16_bf16 v[80:95], v[192:195], v[96:99], v[80:95]
    ds_read_b64_tr_b16 v[120:121], v51 offset:16384
    ds_read_b64_tr_b16 v[122:123], v51 offset:16896
    v_mfma_f32_16x16x32_bf16 v[60:63], v[56:59], v[96:99], v[60:63]
    v_mov_b32 v13, v12
    s_nop 1
    v_permlane32_swap_b32 v12, v13
    v_mul_f32 v24, v24, v12
    v_mul_f32 v25, v25, v12
    v_mul_f32 v26, v26, v12
    v_mul_f32 v27, v27, v12
    v_mul_f32 v28, v28, v12
    v_mul_f32 v29, v29, v12
    v_mfma_f32_32x32x16_bf16 v[80:95], v[196:199], v[100:103], v[80:95]
    ds_read_b64_tr_b16 v[124:125], v51 offset:18432
    ds_read_b64_tr_b16 v[126:127], v51 offset:18944
    v_mfma_f32_16x16x32_bf16 v[60:63], v[56:59], v[100:103], v[60:63]
    v_mul_f32 v30, v30, v12
    v_mul_f32 v31, v31, v12
    v_mul_f32 v64, v64, v13
    v_mul_f32 v65, v65, v13
    v_mul_f32 v66, v66, v13
    v_mul_f32 v67, v67, v13
    v_mul_f32 v68, v68, v13
    v_mul_f32 v69, v69, v13
    v_mul_f32 v70, v70, v13
    v_mfma_f32_32x32x16_bf16 v[80:95], v[200:203], v[104:107], v[80:95]
    v_mul_f32 v71, v71, v13
    v_cvt_pk_bf16_f32 v16, v24, v25
    v_cvt_pk_bf16_f32 v17, v26, v27
    v_cvt_pk_bf16_f32 v18, v28, v29
    v_cvt_pk_bf16_f32 v19, v30, v31
    v_cvt_pk_bf16_f32 v20, v64, v65
    v_cvt_pk_bf16_f32 v21, v66, v67
    v_cvt_pk_bf16_f32 v22, v68, v69
    v_cvt_pk_bf16_f32 v23, v70, v71
    v_fma_f32 v24, v72, v41, v10
    v_fma_f32 v25, v73, v41, v10
    v_fma_f32 v26, v74, v41, v10
    v_fma_f32 v27, v75, v41, v10
    v_fma_f32 v28, v76, v41, v10
    v_mfma_f32_32x32x16_bf16 v[80:95], v[204:207], v[108:111], v[80:95]
    v_fma_f32 v29, v77, v41, v10
    v_fma_f32 v30, v78, v41, v10
    v_fma_f32 v31, v79, v41, v10
    v_fma_f32 v72, -v72, v41, v11
    v_fma_f32 v73, -v73, v41, v11
    v_fma_f32 v74, -v74, v41, v11
    v_fma_f32 v75, -v75, v41, v11
    v_fma_f32 v76, -v76, v41, v11
    v_fma_f32 v77, -v77, v41, v11
    v_fma_f32 v78, -v78, v41, v11
    v_fma_f32 v79, -v79, v41, v11
    s_waitcnt vmcnt(11) lgkmcnt(0)
    s_barrier
    v_mfma_f32_32x32x16_bf16 v[80:95], v[208:211], v[112:115], v[80:95]
    ds_read_b64_tr_b16 v[96:97], v48 offset:32768
    ds_read_b64_tr_b16 v[98:99], v48 offset:33280
    v_exp_f32 v24, v24
    v_exp_f32 v25, v25
    v_exp_f32 v26, v26
    v_exp_f32 v27, v27
    v_exp_f32 v28, v28
    v_exp_f32 v29, v29
    v_mfma_f32_32x32x16_bf16 v[80:95], v[212:215], v[116:119], v[80:95]
    ds_read_b64_tr_b16 v[100:101], v48 offset:34816
    ds_read_b64_tr_b16 v[102:103], v48 offset:35328
    ds_read_b64_tr_b16 v[104:105], v49 offset:32768
    ds_read_b64_tr_b16 v[106:107], v49 offset:33280
    v_exp_f32 v30, v30
    v_exp_f32 v31, v31
    v_exp_f32 v72, v72
    v_exp_f32 v73, v73
    v_mfma_f32_32x32x16_bf16 v[80:95], v[216:219], v[120:123], v[80:95]
    ds_read_b64_tr_b16 v[108:109], v49 offset:34816
    ds_read_b64_tr_b16 v[110:111], v49 offset:35328
    v_exp_f32 v74, v74
    v_exp_f32 v75, v75
    v_exp_f32 v76, v76
    v_exp_f32 v77, v77
    v_exp_f32 v78, v78
    v_exp_f32 v79, v79
    v_mfma_f32_32x32x16_bf16 v[80:95], v[220:223], v[124:127], v[80:95]
    ds_read_b64_tr_b16 v[112:113], v50 offset:32768
    ds_read_b64_tr_b16 v[114:115], v50 offset:33280
    ds_read_b64_tr_b16 v[116:117], v50 offset:34816
    ds_read_b64_tr_b16 v[118:119], v50 offset:35328
    v_add_f32 v12, v24, v25
    v_add_f32 v14, v26, v27
    v_add_f32 v13, v72, v73
    v_add_f32 v15, v74, v75
    v_add_f32 v12, v12, v28
    v_add_f32 v14, v14, v29
    v_add_f32 v13, v13, v76
    v_add_f32 v15, v15, v77
    v_add_f32 v12, v12, v30
    v_add_f32 v14, v14, v31
    s_waitcnt lgkmcnt(4)
    v_mfma_f32_32x32x16_bf16 v[80:95], v[224:227], v[96:99], v[80:95]
    ds_read_b64_tr_b16 v[120:121], v51 offset:32768
    ds_read_b64_tr_b16 v[122:123], v51 offset:33280
    v_mfma_f32_16x16x32_bf16 v[60:63], v[56:59], v[96:99], v[60:63]
    v_add_f32 v13, v13, v78
    v_add_f32 v15, v15, v79
    v_add_f32 v12, v12, v14
    v_add_f32 v13, v13, v15
    s_nop 1
    v_permlane32_swap_b32 v12, v13
    v_add_f32 v12, v12, v13
    v_mfma_f32_32x32x16_bf16 v[80:95], v[228:231], v[100:103], v[80:95]
    ds_read_b64_tr_b16 v[124:125], v51 offset:34816
    ds_read_b64_tr_b16 v[126:127], v51 offset:35328
    v_mfma_f32_16x16x32_bf16 v[60:63], v[56:59], v[100:103], v[60:63]
    v_rcp_f32 v12, v12
    s_nop 0
    v_mov_b32 v13, v12
    s_nop 1
    v_permlane32_swap_b32 v12, v13
    v_mul_f32 v24, v24, v12
    v_mul_f32 v25, v25, v12
    v_mul_f32 v26, v26, v12
    v_mfma_f32_32x32x16_bf16 v[80:95], v[232:235], v[104:107], v[80:95]
    v_mul_f32 v27, v27, v12
    v_mul_f32 v28, v28, v12
    v_mul_f32 v29, v29, v12
    v_mul_f32 v30, v30, v12
    v_mul_f32 v31, v31, v12
    v_mul_f32 v72, v72, v13
    v_mul_f32 v73, v73, v13
    v_mul_f32 v74, v74, v13
    v_mul_f32 v75, v75, v13
    v_mul_f32 v76, v76, v13
    v_mul_f32 v77, v77, v13
    v_mul_f32 v78, v78, v13
    v_mul_f32 v79, v79, v13
    v_mfma_f32_32x32x16_bf16 v[80:95], v[236:239], v[108:111], v[80:95]
    ds_write_b32 v40, v60
    v_cvt_pk_bf16_f32 v24, v24, v25
    v_cvt_pk_bf16_f32 v25, v26, v27
    v_cvt_pk_bf16_f32 v26, v28, v29
    v_cvt_pk_bf16_f32 v27, v30, v31
    v_cvt_pk_bf16_f32 v28, v72, v73
    v_cvt_pk_bf16_f32 v29, v74, v75
    v_cvt_pk_bf16_f32 v30, v76, v77
    v_cvt_pk_bf16_f32 v31, v78, v79
    s_cmp_lg_u32 s48, 0
    s_cbranch_scc1 L_po5
    s_mov_b32 s11, 0
    s_waitcnt vmcnt(2)
L_pc4:
    v_cmp_eq_u32 vcc, s3, v34
    s_nop 2
    s_cmp_eq_u64 vcc, -1
    s_cbranch_scc1 L_po5
    s_add_u32 s11, s11, 1
    s_cmp_ge_u32 s11, 0x40000
    s_cbranch_scc1 L_po5
    s_sleep 1
    v_and_b32 v34, 0xf0, v33
    v_lshlrev_b32 v34, 7, v34
    buffer_load_dword v34, v34, s[32:35], s17 offen offset:4 sc1
    s_waitcnt vmcnt(0)
    s_branch L_pc4
L_po5:
    s_waitcnt vmcnt(9) lgkmcnt(0)
    s_barrier
    v_mfma_f32_32x32x16_bf16 v[80:95], v[240:243], v[112:115], v[80:95]
    ds_read2_b32 v[8:9], v39 offset0:0 offset1:32
    ds_read2_b32 v[10:11], v39 offset0:64 offset1:96
    ds_read_b64_tr_b16 v[96:97], v48 offset:49152
    ds_read_b64_tr_b16 v[98:99], v48 offset:49664
    s_add_u32 m0, s53, 49152
    s_add_u32 s68, s73, 0
    buffer_load_dwordx4 v44, s[40:43], s68 offen lds
    v_mfma_f32_32x32x16_bf16 v[80:95], v[244:247], v[116:119], v[80:95]
    ds_read_b64_tr_b16 v[100:101], v48 offset:51200
    ds_read_b64_tr_b16 v[102:103], v48 offset:51712
    ds_read_b64_tr_b16 v[104:105], v49 offset:49152
    ds_read_b64_tr_b16 v[106:107], v49 offset:49664
    v_mov_b32 v2, 0
    v_mov_b32 v3, 0
    s_waitcnt lgkmcnt(7)
    v_add_f32 v8, v8, v9
    v_mfma_f32_32x32x16_bf16 v[80:95], v[248:251], v[120:123], v[80:95]
    ds_read_b64_tr_b16 v[108:109], v49 offset:51200
    ds_read_b64_tr_b16 v[110:111], v49 offset:51712
    s_waitcnt lgkmcnt(8)
    v_add_f32 v10, v10, v11
    v_add_f32 v8, v8, v10
    v_cvt_pk_bf16_f32 v9, v8, v8
    v_cvt_pk_bf16_f32 v1, v8, 0
    buffer_load_dwordx4 v45, s[40:43], s68 offen offset:1024 lds
    v_mfma_f32_32x32x16_bf16 v[80:95], v[252:255], v[124:127], v[80:95]
    ds_read_b64_tr_b16 v[112:113], v50 offset:49152
    ds_read_b64_tr_b16 v[114:115], v50 offset:49664
    ds_read_b64_tr_b16 v[116:117], v50 offset:51200
    ds_read_b64_tr_b16 v[118:119], v50 offset:51712
    v_and_b32 v9, 0xffff0000, v9
    v_sub_f32 v9, v8, v9
    v_cvt_pk_bf16_f32 v0, v8, v9
    s_nop 1
    v_mfma_f32_32x32x16_bf16 v[80:95], v[52:55], v[0:3], v[80:95]
    s_add_u32 m0, s53, 65536
    s_add_u32 s68, s73, 458752
    buffer_load_dwordx4 v44, s[40:43], s68 offen lds
    s_waitcnt lgkmcnt(4)
    v_mfma_f32_32x32x16_bf16 v[64:79], v[96:99], v[128:131], 0
    ds_read_b64_tr_b16 v[120:121], v51 offset:49152
    ds_read_b64_tr_b16 v[122:123], v51 offset:49664
    v_mfma_f32_16x16x32_bf16 v[60:63], v[56:59], v[96:99], 0
    ds_read_b128 v[4:7], v38 offset:0
    ds_read_b128 v[12:15], v38 offset:32
    ds_read_b128 v[8:11], v38 offset:64
    ds_read_b128 v[0:3], v38 offset:96
    s_mul_i32 s15, s50, 0xc000
    s_add_u32 s15, s15, 32768
    s_lshl_b32 s12, s49, 12
    s_add_u32 s12, s12, s15
    v_add_u32 v43, s12, v33
    s_waitcnt lgkmcnt(3)
    v_mul_f32 v80, v80, v4
    v_mul_f32 v81, v81, v5
    v_mul_f32 v82, v82, v6
    v_mul_f32 v83, v83, v7
    v_mfma_f32_32x32x16_bf16 v[64:79], v[100:103], v[132:135], v[64:79]
    ds_read_b64_tr_b16 v[124:125], v51 offset:51200
    ds_read_b64_tr_b16 v[126:127], v51 offset:51712
    v_mfma_f32_16x16x32_bf16 v[60:63], v[56:59], v[100:103], v[60:63]
    buffer_load_dwordx4 v45, s[40:43], s68 offen offset:1024 lds
    s_waitcnt lgkmcnt(4)
    v_mul_f32 v84, v84, v12
    v_mul_f32 v85, v85, v13
    v_mul_f32 v86, v86, v14
    v_mul_f32 v87, v87, v15
    s_waitcnt lgkmcnt(2)
    v_mul_f32 v88, v88, v8
    v_mul_f32 v89, v89, v9
    v_mul_f32 v90, v90, v10
    v_mul_f32 v91, v91, v11
    v_mfma_f32_32x32x16_bf16 v[64:79], v[104:107], v[136:139], v[64:79]
    v_mul_f32 v92, v92, v0
    v_mul_f32 v93, v93, v1
    v_mul_f32 v94, v94, v2
    v_mul_f32 v95, v95, v3
    v_cvt_pk_bf16_f32 v80, v80, v81
    v_cvt_pk_bf16_f32 v81, v82, v83
    v_cvt_pk_bf16_f32 v82, v84, v85
    v_cvt_pk_bf16_f32 v83, v86, v87
    v_cvt_pk_bf16_f32 v84, v88, v89
    v_cvt_pk_bf16_f32 v85, v90, v91
    v_cvt_pk_bf16_f32 v86, v92, v93
    v_cvt_pk_bf16_f32 v87, v94, v95
    v_and_b32 v88, v80, v32
    v_and_b32 v89, v81, v32
    v_and_b32 v90, v82, v32
    v_and_b32 v91, v83, v32
    v_mfma_f32_32x32x16_bf16 v[64:79], v[108:111], v[140:143], v[64:79]
    v_and_b32 v92, v84, v32
    v_and_b32 v93, v85, v32
    v_and_b32 v94, v86, v32
    v_and_b32 v95, v87, v32
    v_xor_b32 v80, v80, v88
    v_xor_b32 v81, v81, v89
    v_xor_b32 v82, v82, v90
    v_xor_b32 v83, v83, v91
    v_xor_b32 v84, v84, v92
    v_xor_b32 v85, v85, v93
    v_xor_b32 v86, v86, v94
    v_xor_b32 v87, v87, v95
    s_waitcnt vmcnt(11) lgkmcnt(0)
    s_barrier
    v_mfma_f32_32x32x16_bf16 v[64:79], v[112:115], v[144:147], v[64:79]
    v_add_u32 v48, 0x8000, v48
    v_add_u32 v49, 0x8000, v49
    v_add_u32 v50, 0x8000, v50
    v_add_u32 v51, 0x8000, v51
    ds_read_b64_tr_b16 v[96:97], v48 offset:32768
    ds_read_b64_tr_b16 v[98:99], v48 offset:33280
    s_add_u32 m0, s53, 98304
    s_add_u32 s68, s73, 917504
    buffer_load_dwordx4 v44, s[40:43], s68 offen lds
    v_add_u32 v8, 157696, v33
    ds_read_b128 v[0:3], v8
    ds_read_b128 v[4:7], v8 offset:1024
    s_waitcnt lgkmcnt(1)
    v_mfma_f32_32x32x16_bf16 v[128:143], v[16:19], v[0:3], 0
    v_mfma_f32_32x32x16_bf16 v[64:79], v[116:119], v[148:151], v[64:79]
    ds_read_b64_tr_b16 v[100:101], v48 offset:34816
    ds_read_b64_tr_b16 v[102:103], v48 offset:35328
    ds_read_b64_tr_b16 v[104:105], v49 offset:32768
    ds_read_b64_tr_b16 v[106:107], v49 offset:33280
    buffer_load_dwordx4 v45, s[40:43], s68 offen offset:1024 lds
    s_waitcnt lgkmcnt(4)
    v_mfma_f32_32x32x16_bf16 v[128:143], v[20:23], v[4:7], v[128:143]
    s_nop 11
    v_cvt_pk_bf16_f32 v16, v128, v129
    v_cvt_pk_bf16_f32 v17, v130, v131
    v_cvt_pk_bf16_f32 v18, v132, v133
    v_mfma_f32_32x32x16_bf16 v[64:79], v[120:123], v[152:155], v[64:79]
    ds_read_b64_tr_b16 v[108:109], v49 offset:34816
    ds_read_b64_tr_b16 v[110:111], v49 offset:35328
    v_cvt_pk_bf16_f32 v19, v134, v135
    v_cvt_pk_bf16_f32 v20, v136, v137
    v_cvt_pk_bf16_f32 v21, v138, v139
    v_cvt_pk_bf16_f32 v22, v140, v141
    v_cvt_pk_bf16_f32 v23, v142, v143
    v_add_f32 v8, v128, v132
    v_add_f32 v9, v129, v133
    v_add_f32 v10, v130, v134
    v_add_f32 v11, v131, v135
    v_add_f32 v12, v136, v140
    v_add_f32 v13, v137, v141
    v_add_f32 v14, v138, v142
    v_add_f32 v15, v139, v143
    v_add_f32 v8, v8, v12
    v_add_f32 v9, v9, v13
    v_add_f32 v10, v10, v14
    v_add_f32 v11, v11, v15
    v_add_f32 v8, v8, v9
    v_add_f32 v10, v10, v11
    v_add_f32 v8, v8, v10
    ds_write_b32 v36, v8 offset:0
    v_mfma_f32_32x32x16_bf16 v[128:143], v[24:27], v[0:3], 0
    v_mfma_f32_32x32x16_bf16 v[64:79], v[124:127], v[156:159], v[64:79]
    ds_read_b64_tr_b16 v[112:113], v50 offset:32768
    ds_read_b64_tr_b16 v[114:115], v50 offset:33280
    ds_read_b64_tr_b16 v[116:117], v50 offset:34816
    ds_read_b64_tr_b16 v[118:119], v50 offset:35328
    s_waitcnt vmcnt(8)
    v_and_b32 v34, 0x380, v33
    buffer_load_dword v34, v34, s[32:35], s81 offen offset:1024 sc1
    v_mfma_f32_32x32x16_bf16 v[128:143], v[28:31], v[4:7], v[128:143]
    s_nop 11
    v_cvt_pk_bf16_f32 v24, v128, v129
    v_mfma_f32_32x32x16_bf16 v[64:79], v[96:99], v[160:163], v[64:79]
    ds_read_b64_tr_b16 v[120:121], v51 offset:32768
    ds_read_b64_tr_b16 v[122:123], v51 offset:33280
    v_mfma_f32_16x16x32_bf16 v[60:63], v[56:59], v[96:99], v[60:63]
    s_add_u32 m0, s53, 114688
    s_add_u32 s68, s73, 1376256
    buffer_load_dwordx4 v44, s[40:43], s68 offen lds
    v_cvt_pk_bf16_f32 v25, v130, v131
    v_cvt_pk_bf16_f32 v26, v132, v133
    v_cvt_pk_bf16_f32 v27, v134, v135
    v_cvt_pk_bf16_f32 v28, v136, v137
    v_cvt_pk_bf16_f32 v29, v138, v139
    v_cvt_pk_bf16_f32 v30, v140, v141
    v_cvt_pk_bf16_f32 v31, v142, v143
    v_add_f32 v8, v128, v132
    v_add_f32 v9, v129, v133
    v_add_f32 v10, v130, v134
    v_add_f32 v11, v131, v135
    v_add_f32 v12, v136, v140
    v_add_f32 v13, v137, v141
    v_add_f32 v14, v138, v142
    v_add_f32 v15, v139, v143
    v_add_f32 v8, v8, v12
    v_add_f32 v9, v9, v13
    v_add_f32 v10, v10, v14
    s_waitcnt lgkmcnt(0)
    v_mfma_f32_32x32x16_bf16 v[64:79], v[100:103], v[164:167], v[64:79]
    ds_read_b64_tr_b16 v[124:125], v51 offset:34816
    ds_read_b64_tr_b16 v[126:127], v51 offset:35328
    v_mfma_f32_16x16x32_bf16 v[60:63], v[56:59], v[100:103], v[60:63]
    v_add_f32 v11, v11, v15
    v_add_f32 v8, v8, v9
    v_add_f32 v10, v10, v11
    v_add_f32 v8, v8, v10
    ds_write_b32 v36, v8 offset:1024
    s_nop 0
    v_mfma_f32_32x32x16_bf16 v[0:15], v[16:19], v[88:91], 0
    v_mfma_f32_32x32x16_bf16 v[0:15], v[20:23], v[92:95], v[0:15]
    v_mfma_f32_32x32x16_bf16 v[64:79], v[104:107], v[168:171], v[64:79]
    buffer_load_dwordx4 v45, s[40:43], s68 offen offset:1024 lds
    v_mfma_f32_32x32x16_bf16 v[0:15], v[24:27], v[80:83], v[0:15]
    v_mfma_f32_32x32x16_bf16 v[0:15], v[28:31], v[84:87], v[0:15]
    v_mfma_f32_32x32x16_bf16 v[64:79], v[108:111], v[172:175], v[64:79]
    s_nop 10
    ds_write_b128 v43, v[0:3] offset:0
    ds_write_b128 v43, v[4:7] offset:1024
    ds_write_b128 v43, v[8:11] offset:2048
    ds_write_b128 v43, v[12:15] offset:3072
    s_waitcnt lgkmcnt(0)
    s_barrier
    v_mfma_f32_32x32x16_bf16 v[64:79], v[112:115], v[176:179], v[64:79]
    v_lshrrev_b32 v92, 2, v33
    s_lshl_b32 s12, s49, 10
    s_add_u32 s12, s12, s15
    v_add_u32 v43, s12, v92
    ds_read2st64_b32 v[0:1], v43 offset0:0 offset1:1
    ds_read2st64_b32 v[2:3], v43 offset0:2 offset1:3
    ds_read2st64_b32 v[4:5], v43 offset0:16 offset1:17
    ds_read2st64_b32 v[6:7], v43 offset0:18 offset1:19
    ds_read2st64_b32 v[8:9], v43 offset0:32 offset1:33
    ds_read2st64_b32 v[10:11], v43 offset0:34 offset1:35
    ds_read2st64_b32 v[12:13], v43 offset0:48 offset1:49
    ds_read2st64_b32 v[14:15], v43 offset0:50 offset1:51
    s_lshl_b32 s12, s50, 11
    s_add_u32 s12, s12, 159744
    v_lshl_add_u32 v36, v33, 1, s12
    ds_read_b128 v[80:83], v36
    ds_read_b128 v[84:87], v36 offset:16
    v_add_u32 v48, 0xfffe8000, v48
    v_add_u32 v49, 0xfffe8000, v49
    v_add_u32 v50, 0xfffe8000, v50
    v_add_u32 v51, 0xfffe8000, v51
    ds_read_b64_tr_b16 v[96:97], v48 offset:0
    ds_read_b64_tr_b16 v[98:99], v48 offset:512
    s_add_u32 m0, s53, 131072
    s_add_u32 s68, s73, 65536
    buffer_load_dwordx4 v44, s[40:43], s68 offen lds
    v_mfma_f32_32x32x16_bf16 v[64:79], v[116:119], v[180:183], v[64:79]
    ds_read_b64_tr_b16 v[100:101], v48 offset:2048
    ds_read_b64_tr_b16 v[102:103], v48 offset:2560
    ds_read_b64_tr_b16 v[104:105], v49 offset:0
    ds_read_b64_tr_b16 v[106:107], v49 offset:512
    s_lshl_b32 s69, s52, 13
    s_add_u32 s69, s69, s54
    s_add_u32 s69, s69, 9437184
    s_waitcnt lgkmcnt(8)
    v_add_f32 v0, v0, v4
    v_add_f32 v1, v1, v5
    v_add_f32 v2, v2, v6
    v_add_f32 v3, v3, v7
    v_add_f32 v8, v8, v12
    v_add_f32 v9, v9, v13
    v_add_f32 v10, v10, v14
    v_add_f32 v11, v11, v15
    v_add_f32 v88, v0, v8
    v_add_f32 v89, v1, v9
    v_add_f32 v90, v2, v10
    v_add_f32 v91, v3, v11
    v_mfma_f32_32x32x16_bf16 v[64:79], v[120:123], v[184:187], v[64:79]
    ds_read_b64_tr_b16 v[108:109], v49 offset:2048
    ds_read_b64_tr_b16 v[110:111], v49 offset:2560
    buffer_atomic_add_f32 v88, v92, s[32:35], s69 offen offset:0
    buffer_atomic_add_f32 v89, v92, s[32:35], s69 offen offset:256
    buffer_atomic_add_f32 v90, v92, s[32:35], s69 offen offset:512
    buffer_atomic_add_f32 v91, v92, s[32:35], s69 offen offset:768
    s_waitcnt lgkmcnt(2)
    v_add_f32 v80, v80, v84
    v_add_f32 v81, v81, v85
    v_add_f32 v82, v82, v86
    v_mfma_f32_32x32x16_bf16 v[64:79], v[124:127], v[188:191], v[64:79]
    ds_read_b64_tr_b16 v[112:113], v50 offset:0
    ds_read_b64_tr_b16 v[114:115], v50 offset:512
    ds_read_b64_tr_b16 v[116:117], v50 offset:2048
    ds_read_b64_tr_b16 v[118:119], v50 offset:2560
    v_add_f32 v83, v83, v87
    v_add_f32 v80, v80, v81
    v_add_f32 v82, v82, v83
    v_add_f32 v80, v80, v82
    s_lshl1_add_u32 s19, s52, s50
    s_lshl_b32 s19, s19, 12
    s_add_u32 s19, s19, 10485760
    v_and_b32 v84, 28, v92
    v_bfe_u32 v85, v92, 5, 2
    v_lshl_add_u32 v84, v85, 10, v84
    v_lshrrev_b32 v85, 7, v92
    v_lshl_add_u32 v84, v85, 5, v84
    v_lshl_add_u32 v84, s49, 30, v84
    buffer_atomic_add_f32 v80, v84, s[32:35], s19 offen
    v_mfma_f32_32x32x16_bf16 v[64:79], v[96:99], v[192:195], v[64:79]
    ds_read_b64_tr_b16 v[120:121], v51 offset:0
    ds_read_b64_tr_b16 v[122:123], v51 offset:512
    v_mfma_f32_16x16x32_bf16 v[60:63], v[56:59], v[96:99], v[60:63]
    buffer_load_dwordx4 v45, s[40:43], s68 offen offset:1024 lds
    v_mfma_f32_32x32x16_bf16 v[64:79], v[100:103], v[196:199], v[64:79]
    ds_read_b64_tr_b16 v[124:125], v51 offset:2048
    ds_read_b64_tr_b16 v[126:127], v51 offset:2560
    v_mfma_f32_16x16x32_bf16 v[60:63], v[56:59], v[100:103], v[60:63]
    v_mfma_f32_32x32x16_bf16 v[64:79], v[104:107], v[200:203], v[64:79]
    s_waitcnt lgkmcnt(4)
    v_mfma_f32_32x32x16_bf16 v[64:79], v[108:111], v[204:207], v[64:79]
    s_cmp_lg_u32 s48, 0
    s_cbranch_scc1 L_po12
    s_mov_b32 s11, 0
    s_waitcnt vmcnt(9)
L_pc11:
    v_cmp_eq_u32 vcc, s3, v34
    s_nop 2
    s_cmp_eq_u64 vcc, -1
    s_cbranch_scc1 L_po12
    s_add_u32 s11, s11, 1
    s_cmp_ge_u32 s11, 0x40000
    s_cbranch_scc1 L_po12
    s_sleep 1
    v_and_b32 v34, 0x380, v33
    buffer_load_dword v34, v34, s[32:35], s81 offen offset:1024 sc1
    s_waitcnt vmcnt(0)
    s_branch L_pc11
L_po12:
    s_waitcnt vmcnt(1) lgkmcnt(0)
    s_barrier
    v_mfma_f32_32x32x16_bf16 v[64:79], v[112:115], v[208:211], v[64:79]
    s_cmp_lg_u32 s48, 0
    s_cbranch_scc1 L_w02
    v_mov_b32 v61, s3
    buffer_store_dword v61, off, s[32:35], s16 offset:0 sc1
L_w02:
    ds_read_b64_tr_b16 v[96:97], v48 offset:16384
    ds_read_b64_tr_b16 v[98:99], v48 offset:16896
    s_add_u32 s68, s70, 0
    buffer_load_dwordx4 v[128:131], v33, s[32:35], s68 offen sc1
    v_mfma_f32_32x32x16_bf16 v[64:79], v[116:119], v[212:215], v[64:79]
    ds_read_b64_tr_b16 v[100:101], v48 offset:18432
    ds_read_b64_tr_b16 v[102:103], v48 offset:18944
    ds_read_b64_tr_b16 v[104:105], v49 offset:16384
    ds_read_b64_tr_b16 v[106:107], v49 offset:16896
    v_mfma_f32_32x32x16_bf16 v[64:79], v[120:123], v[216:219], v[64:79]
    ds_read_b64_tr_b16 v[108:109], v49 offset:18432
    ds_read_b64_tr_b16 v[110:111], v49 offset:18944
    buffer_load_dwordx4 v[132:135], v33, s[32:35], s68 offen offset:1024 sc1
    v_mfma_f32_32x32x16_bf16 v[64:79], v[124:127], v[220:223], v[64:79]
    ds_read_b64_tr_b16 v[112:113], v50 offset:16384
    ds_read_b64_tr_b16 v[114:115], v50 offset:16896
    ds_read_b64_tr_b16 v[116:117], v50 offset:18432
    ds_read_b64_tr_b16 v[118:119], v50 offset:18944
    s_waitcnt lgkmcnt(10)
    v_mfma_f32_32x32x16_bf16 v[64:79], v[96:99], v[224:227], v[64:79]
    ds_read_b64_tr_b16 v[120:121], v51 offset:16384
    ds_read_b64_tr_b16 v[122:123], v51 offset:16896
    v_mfma_f32_16x16x32_bf16 v[60:63], v[56:59], v[96:99], v[60:63]
    s_add_u32 s68, s70, 28672
    buffer_load_dwordx4 v[136:139], v33, s[32:35], s68 offen sc1
    s_waitcnt lgkmcnt(10)
    v_mfma_f32_32x32x16_bf16 v[64:79], v[100:103], v[228:231], v[64:79]
    ds_read_b64_tr_b16 v[124:125], v51 offset:18432
    ds_read_b64_tr_b16 v[126:127], v51 offset:18944
    v_mfma_f32_16x16x32_bf16 v[60:63], v[56:59], v[100:103], v[60:63]
    s_waitcnt lgkmcnt(9)
    v_mfma_f32_32x32x16_bf16 v[64:79], v[104:107], v[232:235], v[64:79]
    buffer_load_dwordx4 v[140:143], v33, s[32:35], s68 offen offset:1024 sc1
    s_waitcnt lgkmcnt(8)
    v_mfma_f32_32x32x16_bf16 v[64:79], v[108:111], v[236:239], v[64:79]
    s_nop 2
    ds_write_b32 v40, v60
    s_waitcnt lgkmcnt(0)
    s_barrier
    s_add_u32 s68, s70, 57344
    buffer_load_dwordx4 v[144:147], v33, s[32:35], s68 offen sc1
    v_mfma_f32_32x32x16_bf16 v[64:79], v[112:115], v[240:243], v[64:79]
    ds_read2_b32 v[8:9], v39 offset0:0 offset1:32
    ds_read2_b32 v[10:11], v39 offset0:64 offset1:96
    v_lshrrev_b32 v49, 9, v33
    v_bfe_u32 v50, v33, 6, 2
    v_lshl_add_u32 v49, v49, 2, v50
    v_bfe_u32 v48, v33, 8, 1
    v_lshlrev_b32 v48, 5, v48
    v_bfe_u32 v51, v33, 4, 2
    buffer_load_dwordx4 v[148:151], v33, s[32:35], s68 offen offset:1024 sc1
    v_mfma_f32_32x32x16_bf16 v[64:79], v[116:119], v[244:247], v[64:79]
    v_lshl_add_u32 v48, v51, 3, v48
    v_lshrrev_b32 v50, 1, v50
    v_lshl_add_u32 v48, v50, 6, v48
    v_lshl_add_u32 v48, v49, 7, v48
    v_lshl_add_u32 v48, s49, 12, v48
    v_xor_b32 v49, 64, v48
    v_mfma_f32_32x32x16_bf16 v[64:79], v[120:123], v[248:251], v[64:79]
    ds_read_b64_tr_b16 v[96:97], v48 offset:49152
    ds_read_b64_tr_b16 v[98:99], v48 offset:50176
    ds_read_b64_tr_b16 v[100:101], v49 offset:49152
    ds_read_b64_tr_b16 v[102:103], v49 offset:50176
    ds_read_b64_tr_b16 v[104:105], v48 offset:51200
    ds_read_b64_tr_b16 v[106:107], v48 offset:52224
    ds_read_b64_tr_b16 v[108:109], v49 offset:51200
    ds_read_b64_tr_b16 v[110:111], v49 offset:52224
    s_add_u32 s68, s70, 86016
    buffer_load_dwordx4 v[152:155], v33, s[32:35], s68 offen sc1
    v_mfma_f32_32x32x16_bf16 v[64:79], v[124:127], v[252:255], v[64:79]
    v_lshlrev_b32 v12, 16, v35
    v_mov_b32 v2, v35
    v_mov_b32 v3, 0
    s_waitcnt lgkmcnt(8)
    v_add_f32 v8, v8, v9
    v_add_f32 v10, v10, v11
    v_add_f32 v8, v8, v10
    v_cvt_pk_bf16_f32 v9, v8, v8
    v_cvt_pk_bf16_f32 v1, v8, v12
    v_and_b32 v9, 0xffff0000, v9
    v_sub_f32 v9, v8, v9
    v_cvt_pk_bf16_f32 v0, v8, v9
    buffer_load_dwordx4 v[156:159], v33, s[32:35], s68 offen offset:1024 sc1
    s_nop 0
    v_mfma_f32_32x32x16_bf16 v[64:79], v[0:3], v[52:55], v[64:79]
    s_lshl_b32 s69, s66, 5
    s_add_u32 s69, s69, s55
    s_nop 9
    v_mul_f32 v64, v64, v41
    v_exp_f32 v24, v64
    v_mul_f32 v65, v65, v41
    v_fma_f32 v16, v24, -0.5, -1.0
    v_exp_f32 v25, v65
    v_mul_f32 v66, v66, v41
    v_fma_f32 v24, v24, v16, -1.0
    v_fma_f32 v17, v25, -0.5, -1.0
    v_exp_f32 v26, v66
    v_mul_f32 v67, v67, v41
    v_rcp_f32 v24, v24
    v_fma_f32 v25, v25, v17, -1.0
    v_fma_f32 v18, v26, -0.5, -1.0
    v_exp_f32 v27, v67
    v_mul_f32 v68, v68, v41
    v_fma_f32 v64, v64, v24, v64
    v_rcp_f32 v25, v25
    v_fma_f32 v26, v26, v18, -1.0
    v_fma_f32 v19, v27, -0.5, -1.0
    v_exp_f32 v28, v68
    v_mul_f32 v69, v69, v41
    v_fma_f32 v65, v65, v25, v65
    v_rcp_f32 v26, v26
    v_fma_f32 v27, v27, v19, -1.0
    v_fma_f32 v16, v28, -0.5, -1.0
    v_exp_f32 v29, v69
    s_waitcnt lgkmcnt(0)
    s_barrier
    v_add_u32 v48, 0x10000, v48
    v_add_u32 v49, 0x10000, v49
    ds_read_b64_tr_b16 v[112:113], v48 offset:0
    ds_read_b64_tr_b16 v[114:115], v48 offset:1024
    ds_read_b64_tr_b16 v[116:117], v49 offset:0
    ds_read_b64_tr_b16 v[118:119], v49 offset:1024
    ds_read_b64_tr_b16 v[120:121], v48 offset:2048
    ds_read_b64_tr_b16 v[122:123], v48 offset:3072
    ds_read_b64_tr_b16 v[124:125], v49 offset:2048
    ds_read_b64_tr_b16 v[126:127], v49 offset:3072
    s_add_u32 m0, s53, 0
    s_add_u32 s68, s73, 524288
    buffer_load_dwordx4 v44, s[40:43], s68 offen lds
    s_waitcnt vmcnt(7)
    v_mfma_f32_32x32x16_bf16 v[224:239], v[96:99], v[128:131], 0
    buffer_load_dwordx4 v45, s[40:43], s68 offen offset:1024 lds
    v_mul_f32 v70, v70, v41
    v_fma_f32 v66, v66, v26, v66
    v_rcp_f32 v27, v27
    v_fma_f32 v28, v28, v16, -1.0
    v_fma_f32 v17, v29, -0.5, -1.0
    v_exp_f32 v30, v70
    v_mul_f32 v71, v71, v41
    v_fma_f32 v67, v67, v27, v67
    v_rcp_f32 v28, v28
    v_fma_f32 v29, v29, v17, -1.0
    v_fma_f32 v18, v30, -0.5, -1.0
    v_exp_f32 v31, v71
    v_fma_f32 v68, v68, v28, v68
    v_rcp_f32 v29, v29
    v_fma_f32 v30, v30, v18, -1.0
    v_fma_f32 v19, v31, -0.5, -1.0
    v_fma_f32 v69, v69, v29, v69
    v_rcp_f32 v30, v30
    v_fma_f32 v31, v31, v19, -1.0
    v_fma_f32 v70, v70, v30, v70
    v_rcp_f32 v31, v31
    v_mfma_f32_32x32x16_bf16 v[192:207], v[100:103], v[128:131], 0
    s_add_u32 m0, s53, 32768
    s_add_u32 s68, s73, 983040
    buffer_load_dwordx4 v44, s[40:43], s68 offen lds
    v_fma_f32 v71, v71, v31, v71
    v_cvt_pk_bf16_f32 v16, v64, v65
    v_cvt_pk_bf16_f32 v17, v66, v67
    v_cvt_pk_bf16_f32 v18, v68, v69
    v_cvt_pk_bf16_f32 v19, v70, v71
    buffer_store_dwordx4 v[16:19], v42, s[32:35], s69 offen offset:0 sc1
    v_mul_f32 v72, v72, v41
    v_exp_f32 v24, v72
    v_mul_f32 v73, v73, v41
    v_fma_f32 v20, v24, -0.5, -1.0
    v_exp_f32 v25, v73
    v_mul_f32 v74, v74, v41
    v_fma_f32 v24, v24, v20, -1.0
    v_fma_f32 v21, v25, -0.5, -1.0
    v_exp_f32 v26, v74
    v_mul_f32 v75, v75, v41
    v_rcp_f32 v24, v24
    v_fma_f32 v25, v25, v21, -1.0
    v_fma_f32 v22, v26, -0.5, -1.0
    v_mfma_f32_32x32x16_bf16 v[224:239], v[104:107], v[132:135], v[224:239]
    buffer_load_dwordx4 v45, s[40:43], s68 offen offset:1024 lds
    v_exp_f32 v27, v75
    v_mul_f32 v76, v76, v41
    v_fma_f32 v72, v72, v24, v72
    v_rcp_f32 v25, v25
    v_fma_f32 v26, v26, v22, -1.0
    v_fma_f32 v23, v27, -0.5, -1.0
    v_exp_f32 v28, v76
    v_mul_f32 v77, v77, v41
    v_fma_f32 v73, v73, v25, v73
    v_rcp_f32 v26, v26
    v_fma_f32 v27, v27, v23, -1.0
    v_fma_f32 v20, v28, -0.5, -1.0
    v_exp_f32 v29, v77
    v_mul_f32 v78, v78, v41
    v_fma_f32 v74, v74, v26, v74
    v_rcp_f32 v27, v27
    v_fma_f32 v28, v28, v20, -1.0
    v_fma_f32 v21, v29, -0.5, -1.0
    v_exp_f32 v30, v78
    v_mul_f32 v79, v79, v41
    v_mfma_f32_32x32x16_bf16 v[192:207], v[108:111], v[132:135], v[192:207]
    v_fma_f32 v75, v75, v27, v75
    v_rcp_f32 v28, v28
    v_fma_f32 v29, v29, v21, -1.0
    v_fma_f32 v22, v30, -0.5, -1.0
    v_exp_f32 v31, v79
    v_fma_f32 v76, v76, v28, v76
    v_rcp_f32 v29, v29
    v_fma_f32 v30, v30, v22, -1.0
    v_fma_f32 v23, v31, -0.5, -1.0
    v_fma_f32 v77, v77, v29, v77
    v_rcp_f32 v30, v30
    v_fma_f32 v31, v31, v23, -1.0
    v_fma_f32 v78, v78, v30, v78
    v_rcp_f32 v31, v31
    s_nop 0
    v_fma_f32 v79, v79, v31, v79
    v_cvt_pk_bf16_f32 v20, v72, v73
    v_cvt_pk_bf16_f32 v21, v74, v75
    v_cvt_pk_bf16_f32 v22, v76, v77
    v_cvt_pk_bf16_f32 v23, v78, v79
    buffer_store_dwordx4 v[20:23], v42, s[32:35], s69 offen offset:1024 sc1
    s_waitcnt lgkmcnt(0)
    s_barrier
    ds_read_b64_tr_b16 v[96:97], v48 offset:32768
    ds_read_b64_tr_b16 v[98:99], v48 offset:33792
    ds_read_b64_tr_b16 v[100:101], v49 offset:32768
    ds_read_b64_tr_b16 v[102:103], v49 offset:33792
    ds_read_b64_tr_b16 v[104:105], v48 offset:34816
    ds_read_b64_tr_b16 v[106:107], v48 offset:35840
    ds_read_b64_tr_b16 v[108:109], v49 offset:34816
    ds_read_b64_tr_b16 v[110:111], v49 offset:35840
    v_and_b32 v34, 0x380, v33
    buffer_load_dword v34, v34, s[32:35], s81 offen offset:1028 sc1
    s_waitcnt vmcnt(11)
    v_mfma_f32_32x32x16_bf16 v[224:239], v[112:115], v[136:139], v[224:239]
    s_add_u32 m0, s53, 81920
    s_add_u32 s68, s73, 1441792
    buffer_load_dwordx4 v44, s[40:43], s68 offen lds
    v_mfma_f32_32x32x16_bf16 v[192:207], v[116:119], v[136:139], v[192:207]
    buffer_load_dwordx4 v45, s[40:43], s68 offen offset:1024 lds
    v_mfma_f32_32x32x16_bf16 v[224:239], v[120:123], v[140:143], v[224:239]
    s_add_u32 m0, s53, 16384
    s_add_u32 s68, s73, 131072
    buffer_load_dwordx4 v44, s[40:43], s68 offen lds
    v_mfma_f32_32x32x16_bf16 v[192:207], v[124:127], v[140:143], v[192:207]
    buffer_load_dwordx4 v45, s[40:43], s68 offen offset:1024 lds
    s_cmp_lg_u32 s48, 0
    s_cbranch_scc1 L_po14
    s_mov_b32 s11, 0
    s_waitcnt vmcnt(4)
L_pc13:
    v_cmp_eq_u32 vcc, s3, v34
    s_nop 2
    s_cmp_eq_u64 vcc, -1
    s_cbranch_scc1 L_po14
    s_add_u32 s11, s11, 1
    s_cmp_ge_u32 s11, 0x40000
    s_cbranch_scc1 L_po14
    s_sleep 1
    v_and_b32 v34, 0x380, v33
    buffer_load_dword v34, v34, s[32:35], s81 offen offset:1028 sc1
    s_waitcnt vmcnt(0)
    s_branch L_pc13
L_po14:
    s_waitcnt lgkmcnt(0)
    s_barrier
    ds_read_b64_tr_b16 v[112:113], v48 offset:49152
    ds_read_b64_tr_b16 v[114:115], v48 offset:50176
    ds_read_b64_tr_b16 v[116:117], v49 offset:49152
    ds_read_b64_tr_b16 v[118:119], v49 offset:50176
    ds_read_b64_tr_b16 v[120:121], v48 offset:51200
    ds_read_b64_tr_b16 v[122:123], v48 offset:52224
    ds_read_b64_tr_b16 v[124:125], v49 offset:51200
    ds_read_b64_tr_b16 v[126:127], v49 offset:52224
    s_add_u32 s68, s70, 4096
    buffer_load_dwordx4 v[176:179], v33, s[32:35], s68 offen sc1
    s_waitcnt vmcnt(14)
    v_mfma_f32_32x32x16_bf16 v[224:239], v[96:99], v[144:147], v[224:239]
    buffer_load_dwordx4 v[180:183], v33, s[32:35], s68 offen offset:1024 sc1
    v_mfma_f32_32x32x16_bf16 v[192:207], v[100:103], v[144:147], v[192:207]
    s_add_u32 s68, s70, 32768
    buffer_load_dwordx4 v[184:187], v33, s[32:35], s68 offen sc1
    v_mfma_f32_32x32x16_bf16 v[224:239], v[104:107], v[148:151], v[224:239]
    buffer_load_dwordx4 v[188:191], v33, s[32:35], s68 offen offset:1024 sc1
    v_mfma_f32_32x32x16_bf16 v[192:207], v[108:111], v[148:151], v[192:207]
    s_waitcnt vmcnt(9) lgkmcnt(0)
    s_barrier
    s_cmp_lg_u32 s48, 0
    s_cbranch_scc1 L_w06
    v_mov_b32 v61, s3
    buffer_store_dword v61, off, s[32:35], s16 offset:8 sc1
L_w06:
    v_add_u32 v48, 0x8000, v48
    v_add_u32 v49, 0x8000, v49
    ds_read_b64_tr_b16 v[96:97], v48 offset:32768
    ds_read_b64_tr_b16 v[98:99], v48 offset:33792
    ds_read_b64_tr_b16 v[100:101], v49 offset:32768
    ds_read_b64_tr_b16 v[102:103], v49 offset:33792
    ds_read_b64_tr_b16 v[104:105], v48 offset:34816
    ds_read_b64_tr_b16 v[106:107], v48 offset:35840
    ds_read_b64_tr_b16 v[108:109], v49 offset:34816
    ds_read_b64_tr_b16 v[110:111], v49 offset:35840
    s_add_u32 s68, s70, 61440
    buffer_load_dwordx4 v[208:211], v33, s[32:35], s68 offen sc1
    v_mfma_f32_32x32x16_bf16 v[224:239], v[112:115], v[152:155], v[224:239]
    buffer_load_dwordx4 v[212:215], v33, s[32:35], s68 offen offset:1024 sc1
    v_mfma_f32_32x32x16_bf16 v[192:207], v[116:119], v[152:155], v[192:207]
    s_add_u32 s68, s70, 90112
    buffer_load_dwordx4 v[216:219], v33, s[32:35], s68 offen sc1
    v_mfma_f32_32x32x16_bf16 v[224:239], v[120:123], v[156:159], v[224:239]
    buffer_load_dwordx4 v[220:223], v33, s[32:35], s68 offen offset:1024 sc1
    v_mfma_f32_32x32x16_bf16 v[192:207], v[124:127], v[156:159], v[192:207]
    s_waitcnt lgkmcnt(0)
    s_barrier
    v_add_u32 v48, 0xfffe8000, v48
    v_add_u32 v49, 0xfffe8000, v49
    ds_read_b64_tr_b16 v[112:113], v48 offset:0
    ds_read_b64_tr_b16 v[114:115], v48 offset:1024
    ds_read_b64_tr_b16 v[116:117], v49 offset:0
    ds_read_b64_tr_b16 v[118:119], v49 offset:1024
    ds_read_b64_tr_b16 v[120:121], v48 offset:2048
    ds_read_b64_tr_b16 v[122:123], v48 offset:3072
    ds_read_b64_tr_b16 v[124:125], v49 offset:2048
    ds_read_b64_tr_b16 v[126:127], v49 offset:3072
    s_add_u32 m0, s53, 49152
    s_add_u32 s68, s73, 589824
    buffer_load_dwordx4 v44, s[40:43], s68 offen lds
    s_waitcnt vmcnt(7)
    v_mfma_f32_32x32x16_bf16 v[224:239], v[96:99], v[176:179], v[224:239]
    buffer_load_dwordx4 v45, s[40:43], s68 offen offset:1024 lds
    v_mfma_f32_32x32x16_bf16 v[192:207], v[100:103], v[176:179], v[192:207]
    s_add_u32 m0, s53, 65536
    s_add_u32 s68, s73, 1048576
    buffer_load_dwordx4 v44, s[40:43], s68 offen lds
    v_mfma_f32_32x32x16_bf16 v[224:239], v[104:107], v[180:183], v[224:239]
    buffer_load_dwordx4 v45, s[40:43], s68 offen offset:1024 lds
    v_mfma_f32_32x32x16_bf16 v[192:207], v[108:111], v[180:183], v[192:207]
    s_waitcnt lgkmcnt(0)
    s_barrier
    ds_read_b64_tr_b16 v[96:97], v48 offset:32768
    ds_read_b64_tr_b16 v[98:99], v48 offset:33792
    ds_read_b64_tr_b16 v[100:101], v49 offset:32768
    ds_read_b64_tr_b16 v[102:103], v49 offset:33792
    ds_read_b64_tr_b16 v[104:105], v48 offset:34816
    ds_read_b64_tr_b16 v[106:107], v48 offset:35840
    ds_read_b64_tr_b16 v[108:109], v49 offset:34816
    ds_read_b64_tr_b16 v[110:111], v49 offset:35840
    v_and_b32 v34, 0x380, v33
    buffer_load_dword v34, v34, s[32:35], s81 offen offset:8 sc1
    s_waitcnt vmcnt(9)
    v_mfma_f32_32x32x16_bf16 v[224:239], v[112:115], v[184:187], v[224:239]
    s_add_u32 m0, s53, 98304
    s_add_u32 s68, s73, 1507328
    buffer_load_dwordx4 v44, s[40:43], s68 offen lds
    v_mfma_f32_32x32x16_bf16 v[192:207], v[116:119], v[184:187], v[192:207]
    buffer_load_dwordx4 v45, s[40:43], s68 offen offset:1024 lds
    v_mfma_f32_32x32x16_bf16 v[224:239], v[120:123], v[188:191], v[224:239]
    s_add_u32 m0, s53, 114688
    s_add_u32 s68, s74, 196608
    buffer_load_dwordx4 v44, s[40:43], s68 offen lds
    v_mfma_f32_32x32x16_bf16 v[192:207], v[124:127], v[188:191], v[192:207]
    buffer_load_dwordx4 v45, s[40:43], s68 offen offset:1024 lds
    s_cmp_lg_u32 s48, 0
    s_cbranch_scc1 L_po16
    s_mov_b32 s11, 0
    s_waitcnt vmcnt(4)
L_pc15:
    v_cmp_eq_u32 vcc, s3, v34
    s_nop 2
    s_cmp_eq_u64 vcc, -1
    s_cbranch_scc1 L_po16
    s_add_u32 s11, s11, 1
    s_cmp_ge_u32 s11, 0x40000
    s_cbranch_scc1 L_po16
    s_sleep 1
    v_and_b32 v34, 0x380, v33
    buffer_load_dword v34, v34, s[32:35], s81 offen offset:8 sc1
    s_waitcnt vmcnt(0)
    s_branch L_pc15
L_po16:
    s_waitcnt lgkmcnt(0)
    s_barrier
    v_add_u32 v48, 0x10000, v48
    v_add_u32 v49, 0x10000, v49
    ds_read_b64_tr_b16 v[112:113], v48 offset:16384
    ds_read_b64_tr_b16 v[114:115], v48 offset:17408
    ds_read_b64_tr_b16 v[116:117], v49 offset:16384
    ds_read_b64_tr_b16 v[118:119], v49 offset:17408
    ds_read_b64_tr_b16 v[120:121], v48 offset:18432
    ds_read_b64_tr_b16 v[122:123], v48 offset:19456
    ds_read_b64_tr_b16 v[124:125], v49 offset:18432
    ds_read_b64_tr_b16 v[126:127], v49 offset:19456
    s_add_u32 s68, s70, 8192
    buffer_load_dwordx4 v[160:163], v33, s[32:35], s68 offen sc1
    s_waitcnt vmcnt(12)
    v_mfma_f32_32x32x16_bf16 v[224:239], v[96:99], v[208:211], v[224:239]
    buffer_load_dwordx4 v[164:167], v33, s[32:35], s68 offen offset:1024 sc1
    v_mfma_f32_32x32x16_bf16 v[192:207], v[100:103], v[208:211], v[192:207]
    s_add_u32 s68, s70, 36864
    buffer_load_dwordx4 v[168:171], v33, s[32:35], s68 offen sc1
    v_mfma_f32_32x32x16_bf16 v[224:239], v[104:107], v[212:215], v[224:239]
    buffer_load_dwordx4 v[172:175], v33, s[32:35], s68 offen offset:1024 sc1
    v_mfma_f32_32x32x16_bf16 v[192:207], v[108:111], v[212:215], v[192:207]
    s_waitcnt lgkmcnt(0)
    s_barrier
    v_add_u32 v48, 0xffff0000, v48
    v_add_u32 v49, 0xffff0000, v49
    ds_read_b64_tr_b16 v[96:97], v48 offset:16384
    ds_read_b64_tr_b16 v[98:99], v48 offset:17408
    ds_read_b64_tr_b16 v[100:101], v49 offset:16384
    ds_read_b64_tr_b16 v[102:103], v49 offset:17408
    ds_read_b64_tr_b16 v[104:105], v48 offset:18432
    ds_read_b64_tr_b16 v[106:107], v48 offset:19456
    ds_read_b64_tr_b16 v[108:109], v49 offset:18432
    ds_read_b64_tr_b16 v[110:111], v49 offset:19456
    s_add_u32 s68, s70, 65536
    buffer_load_dwordx4 v[240:243], v33, s[32:35], s68 offen sc1
    s_waitcnt vmcnt(14)
    v_mfma_f32_32x32x16_bf16 v[224:239], v[112:115], v[216:219], v[224:239]
    buffer_load_dwordx4 v[244:247], v33, s[32:35], s68 offen offset:1024 sc1
    v_mfma_f32_32x32x16_bf16 v[192:207], v[116:119], v[216:219], v[192:207]
    s_add_u32 s68, s70, 94208
    buffer_load_dwordx4 v[248:251], v33, s[32:35], s68 offen sc1
    v_mfma_f32_32x32x16_bf16 v[224:239], v[120:123], v[220:223], v[224:239]
    buffer_load_dwordx4 v[252:255], v33, s[32:35], s68 offen offset:1024 sc1
    v_mfma_f32_32x32x16_bf16 v[192:207], v[124:127], v[220:223], v[192:207]
    s_waitcnt vmcnt(15) lgkmcnt(0)
    s_barrier
    ds_read_b64_tr_b16 v[112:113], v48 offset:49152
    ds_read_b64_tr_b16 v[114:115], v48 offset:50176
    ds_read_b64_tr_b16 v[116:117], v49 offset:49152
    ds_read_b64_tr_b16 v[118:119], v49 offset:50176
    ds_read_b64_tr_b16 v[120:121], v48 offset:51200
    ds_read_b64_tr_b16 v[122:123], v48 offset:52224
    ds_read_b64_tr_b16 v[124:125], v49 offset:51200
    ds_read_b64_tr_b16 v[126:127], v49 offset:52224
    s_add_u32 m0, s53, 131072
    s_add_u32 s68, s74, 1114112
    buffer_load_dwordx4 v44, s[40:43], s68 offen lds
    s_waitcnt vmcnt(7)
    v_mfma_f32_32x32x16_bf16 v[224:239], v[96:99], v[160:163], v[224:239]
    buffer_load_dwordx4 v45, s[40:43], s68 offen offset:1024 lds
    v_mfma_f32_32x32x16_bf16 v[192:207], v[100:103], v[160:163], v[192:207]
    s_add_u32 m0, s53, 0
    s_add_u32 s68, s75, 0
    buffer_load_dwordx4 v44, s[44:47], s68 offen lds
    v_mfma_f32_32x32x16_bf16 v[224:239], v[104:107], v[164:167], v[224:239]
    buffer_load_dwordx4 v45, s[44:47], s68 offen offset:1024 lds
    v_mfma_f32_32x32x16_bf16 v[192:207], v[108:111], v[164:167], v[192:207]
    s_waitcnt lgkmcnt(0)
    s_barrier
    v_add_u32 v48, 0x10000, v48
    v_add_u32 v49, 0x10000, v49
    ds_read_b64_tr_b16 v[96:97], v48 offset:0
    ds_read_b64_tr_b16 v[98:99], v48 offset:1024
    ds_read_b64_tr_b16 v[100:101], v49 offset:0
    ds_read_b64_tr_b16 v[102:103], v49 offset:1024
    ds_read_b64_tr_b16 v[104:105], v48 offset:2048
    ds_read_b64_tr_b16 v[106:107], v48 offset:3072
    ds_read_b64_tr_b16 v[108:109], v49 offset:2048
    ds_read_b64_tr_b16 v[110:111], v49 offset:3072
    v_and_b32 v34, 0x380, v33
    buffer_load_dword v34, v34, s[32:35], s81 offen offset:1032 sc1
    s_waitcnt vmcnt(9)
    v_mfma_f32_32x32x16_bf16 v[224:239], v[112:115], v[168:171], v[224:239]
    s_add_u32 m0, s53, 32768
    s_add_u32 s68, s75, 131072
    buffer_load_dwordx4 v44, s[44:47], s68 offen lds
    v_lshrrev_b32 v56, 7, v33
    v_and_b32 v57, 0x70, v33
    v_mfma_f32_32x32x16_bf16 v[192:207], v[116:119], v[168:171], v[192:207]
    buffer_load_dwordx4 v45, s[44:47], s68 offen offset:1024 lds
    v_lshl_add_u32 v56, v56, 10, v57
    v_mfma_f32_32x32x16_bf16 v[224:239], v[120:123], v[172:175], v[224:239]
    s_add_u32 m0, s53, 81920
    s_add_u32 s68, s75, 262144
    buffer_load_dwordx4 v44, s[44:47], s68 offen lds
    buffer_load_dwordx4 v[52:55], v56, s[24:27], s80 offen
    v_mfma_f32_32x32x16_bf16 v[192:207], v[124:127], v[172:175], v[192:207]
    buffer_load_dwordx4 v45, s[44:47], s68 offen offset:1024 lds
    s_cmp_lg_u32 s48, 0
    s_cbranch_scc1 L_po18
    s_mov_b32 s11, 0
    s_waitcnt vmcnt(5)
L_pc17:
    v_cmp_eq_u32 vcc, s3, v34
    s_nop 2
    s_cmp_eq_u64 vcc, -1
    s_cbranch_scc1 L_po18
    s_add_u32 s11, s11, 1
    s_cmp_ge_u32 s11, 0x40000
    s_cbranch_scc1 L_po18
    s_sleep 1
    v_and_b32 v34, 0x380, v33
    buffer_load_dword v34, v34, s[32:35], s81 offen offset:1032 sc1
    s_waitcnt vmcnt(0)
    s_branch L_pc17
L_po18:
    s_waitcnt vmcnt(8) lgkmcnt(0)
    s_barrier
    ds_read_b64_tr_b16 v[112:113], v48 offset:32768
    ds_read_b64_tr_b16 v[114:115], v48 offset:33792
    ds_read_b64_tr_b16 v[116:117], v49 offset:32768
    ds_read_b64_tr_b16 v[118:119], v49 offset:33792
    ds_read_b64_tr_b16 v[120:121], v48 offset:34816
    ds_read_b64_tr_b16 v[122:123], v48 offset:35840
    ds_read_b64_tr_b16 v[124:125], v49 offset:34816
    ds_read_b64_tr_b16 v[126:127], v49 offset:35840
    s_add_u32 s68, s71, 12288
    buffer_load_dwordx4 v[128:131], v33, s[32:35], s68 offen sc1
    v_mfma_f32_32x32x16_bf16 v[224:239], v[96:99], v[240:243], v[224:239]
    buffer_load_dwordx4 v[132:135], v33, s[32:35], s68 offen offset:1024 sc1
    v_mfma_f32_32x32x16_bf16 v[192:207], v[100:103], v[240:243], v[192:207]
    s_add_u32 s68, s71, 69632
    buffer_load_dwordx4 v[136:139], v33, s[32:35], s68 offen sc1
    v_mfma_f32_32x32x16_bf16 v[224:239], v[104:107], v[244:247], v[224:239]
    buffer_load_dwordx4 v[140:143], v33, s[32:35], s68 offen offset:1024 sc1
    v_mfma_f32_32x32x16_bf16 v[192:207], v[108:111], v[244:247], v[192:207]
    ds_read_b64_tr_b16 v[96:97], v48 offset:49152
    ds_read_b64_tr_b16 v[98:99], v48 offset:50176
    ds_read_b64_tr_b16 v[100:101], v49 offset:49152
    ds_read_b64_tr_b16 v[102:103], v49 offset:50176
    ds_read_b64_tr_b16 v[104:105], v48 offset:51200
    ds_read_b64_tr_b16 v[106:107], v48 offset:52224
    ds_read_b64_tr_b16 v[108:109], v49 offset:51200
    ds_read_b64_tr_b16 v[110:111], v49 offset:52224
    s_add_u32 m0, s53, 16384
    s_add_u32 s68, s75, 393216
    buffer_load_dwordx4 v44, s[44:47], s68 offen lds
    s_waitcnt lgkmcnt(8)
    v_mfma_f32_32x32x16_bf16 v[224:239], v[112:115], v[248:251], v[224:239]
    v_lshrrev_b32 v1, 5, v33
    v_and_b32 v1, 16, v1
    v_and_b32 v2, 0xf0, v33
    v_xor_b32 v1, v1, v2
    v_and_b32 v2, 0x1f0, v33
    v_lshl_add_u32 v1, v2, 4, v1
    v_mfma_f32_32x32x16_bf16 v[192:207], v[116:119], v[248:251], v[192:207]
    buffer_load_dwordx4 v45, s[44:47], s68 offen offset:1024 lds
    s_lshl1_add_u32 s12, s49, s50
    s_add_u32 s12, s12, 12
    v_lshl_add_u32 v0, s12, 13, v1
    v_xor_b32 v1, 32, v0
    v_mfma_f32_32x32x16_bf16 v[224:239], v[120:123], v[252:255], v[224:239]
    v_xor_b32 v2, 64, v0
    v_xor_b32 v3, 96, v0
    v_xor_b32 v4, 128, v0
    v_xor_b32 v5, 160, v0
    v_xor_b32 v6, 192, v0
    v_xor_b32 v7, 224, v0
    v_mfma_f32_32x32x16_bf16 v[192:207], v[124:127], v[252:255], v[192:207]
    v_lshrrev_b32 v8, 7, v33
    v_lshl_add_u32 v8, s48, 3, v8
    v_add_u32 v48, 0x8000, v48
    v_add_u32 v49, 0x8000, v49
    ds_read_b64_tr_b16 v[112:113], v48 offset:32768
    ds_read_b64_tr_b16 v[114:115], v48 offset:33792
    ds_read_b64_tr_b16 v[116:117], v49 offset:32768
    ds_read_b64_tr_b16 v[118:119], v49 offset:33792
    ds_read_b64_tr_b16 v[120:121], v48 offset:34816
    ds_read_b64_tr_b16 v[122:123], v48 offset:35840
    ds_read_b64_tr_b16 v[124:125], v49 offset:34816
    ds_read_b64_tr_b16 v[126:127], v49 offset:35840
    s_waitcnt vmcnt(11)
    v_and_b32 v34, 0x380, v33
    buffer_load_dword v34, v34, s[32:35], s81 offen offset:1036 sc1
    s_waitcnt vmcnt(5) lgkmcnt(8)
    v_mfma_f32_32x32x16_bf16 v[224:239], v[96:99], v[128:131], v[224:239]
    v_bfe_u32 v9, v33, 4, 3
    v_lshlrev_b32 v9, 1, v9
    v_and_b32 v10, 15, v8
    v_xor_b32 v9, v9, v10
    v_lshlrev_b32 v9, 4, v9
    v_mfma_f32_32x32x16_bf16 v[192:207], v[100:103], v[128:131], v[192:207]
    v_lshl_add_u32 v8, v8, 8, v9
    v_add_u32 v8, 98304, v8
    v_xor_b32 v9, 16, v8
    v_mov_b32 v10, 0x3fb8aa3b
    v_lshlrev_b32 v24, 16, v52
    v_mfma_f32_32x32x16_bf16 v[224:239], v[104:107], v[132:135], v[224:239]
    v_and_b32 v25, 0xffff0000, v52
    v_lshlrev_b32 v26, 16, v53
    v_and_b32 v27, 0xffff0000, v53
    v_lshlrev_b32 v28, 16, v54
    v_and_b32 v29, 0xffff0000, v54
    v_mfma_f32_32x32x16_bf16 v[192:207], v[108:111], v[132:135], v[192:207]
    v_lshlrev_b32 v30, 16, v55
    v_and_b32 v31, 0xffff0000, v55
    s_cmp_lg_u32 s48, 0
    s_cbranch_scc1 L_po20
    s_mov_b32 s11, 0
    s_waitcnt vmcnt(0)
L_pc19:
    v_cmp_eq_u32 vcc, s3, v34
    s_nop 2
    s_cmp_eq_u64 vcc, -1
    s_cbranch_scc1 L_po20
    s_add_u32 s11, s11, 1
    s_cmp_ge_u32 s11, 0x40000
    s_cbranch_scc1 L_po20
    s_sleep 1
    v_and_b32 v34, 0x380, v33
    buffer_load_dword v34, v34, s[32:35], s81 offen offset:1036 sc1
    s_waitcnt vmcnt(0)
    s_branch L_pc19
L_po20:
    s_waitcnt lgkmcnt(0)
    s_barrier
    s_add_u32 s68, s72, 0
    buffer_load_dwordx4 v[144:147], v33, s[32:35], s68 offen sc1
    buffer_load_dwordx4 v[148:151], v33, s[32:35], s68 offen offset:1024 sc1
    s_waitcnt vmcnt(5)
    v_mfma_f32_32x32x16_bf16 v[224:239], v[112:115], v[136:139], v[224:239]
    v_mfma_f32_32x32x16_bf16 v[224:239], v[120:123], v[140:143], v[224:239]
    v_add_u32 v48, 0xfffe8000, v48
    v_add_u32 v49, 0xfffe8000, v49
    ds_read_b64_tr_b16 v[96:97], v48 offset:0
    ds_read_b64_tr_b16 v[98:99], v48 offset:1024
    ds_read_b64_tr_b16 v[100:101], v49 offset:0
    ds_read_b64_tr_b16 v[102:103], v49 offset:1024
    v_mfma_f32_32x32x16_bf16 v[192:207], v[116:119], v[136:139], v[192:207]
    v_mfma_f32_32x32x16_bf16 v[192:207], v[124:127], v[140:143], v[192:207]
    ds_read_b64_tr_b16 v[104:105], v48 offset:2048
    ds_read_b64_tr_b16 v[106:107], v48 offset:3072
    ds_read_b64_tr_b16 v[108:109], v49 offset:2048
    ds_read_b64_tr_b16 v[110:111], v49 offset:3072
    s_add_u32 s68, s72, 8192
    buffer_load_dwordx4 v[152:155], v33, s[32:35], s68 offen sc1
    ds_write_b128 v0, v[224:227]
    buffer_load_dwordx4 v[156:159], v33, s[32:35], s68 offen offset:1024 sc1
    ds_write_b128 v1, v[228:231]
    s_add_u32 s68, s72, 16384
    buffer_load_dwordx4 v[176:179], v33, s[32:35], s68 offen sc1
    ds_write_b128 v2, v[232:235]
    buffer_load_dwordx4 v[180:183], v33, s[32:35], s68 offen offset:1024 sc1
    ds_write_b128 v3, v[236:239]
    s_add_u32 s68, s72, 24576
    buffer_load_dwordx4 v[184:187], v33, s[32:35], s68 offen sc1
    ds_write_b128 v4, v[192:195]
    buffer_load_dwordx4 v[188:191], v33, s[32:35], s68 offen offset:1024 sc1
    ds_write_b128 v5, v[196:199]
    ds_write_b128 v6, v[200:203]
    ds_write_b128 v7, v[204:207]
    s_waitcnt lgkmcnt(0)
    s_barrier
    ds_read_b128 v[224:227], v8 offset:0
    ds_read_b128 v[228:231], v9 offset:0
    ds_read_b128 v[232:235], v8 offset:16384
    ds_read_b128 v[236:239], v9 offset:16384
    ds_read_b128 v[192:195], v8 offset:32768
    ds_read_b128 v[196:199], v9 offset:32768
    ds_read_b128 v[200:203], v8 offset:49152
    ds_read_b128 v[204:207], v9 offset:49152
    ds_read_b64_tr_b16 v[112:113], v48 offset:32768
    ds_read_b64_tr_b16 v[114:115], v48 offset:33792
    ds_read_b64_tr_b16 v[116:117], v49 offset:32768
    ds_read_b64_tr_b16 v[118:119], v49 offset:33792
    ds_read_b64_tr_b16 v[120:121], v48 offset:34816
    ds_read_b64_tr_b16 v[122:123], v48 offset:35840
    ds_read_b64_tr_b16 v[124:125], v49 offset:34816
    ds_read_b64_tr_b16 v[126:127], v49 offset:35840
    s_waitcnt vmcnt(6)
    v_mfma_f32_32x32x16_bf16 v[64:79], v[96:99], v[144:147], 0
    s_waitcnt lgkmcnt(13)
    v_add_f32 v224, v224, v232
    v_add_f32 v225, v225, v233
    v_add_f32 v226, v226, v234
    v_add_f32 v227, v227, v235
    s_waitcnt lgkmcnt(12)
    v_add_f32 v228, v228, v236
    v_add_f32 v229, v229, v237
    v_add_f32 v230, v230, v238
    v_add_f32 v231, v231, v239
    s_waitcnt lgkmcnt(7)
    v_add_f32 v192, v192, v200
    v_add_f32 v193, v193, v201
    v_add_f32 v194, v194, v202
    v_add_f32 v195, v195, v203
    v_add_f32 v196, v196, v204
    v_add_f32 v197, v197, v205
    v_add_f32 v198, v198, v206
    v_add_f32 v199, v199, v207
    v_add_f32 v224, v224, v192
    v_add_f32 v225, v225, v193
    v_add_f32 v226, v226, v194
    v_mfma_f32_32x32x16_bf16 v[80:95], v[100:103], v[144:147], 0
    v_add_f32 v227, v227, v195
    v_add_f32 v228, v228, v196
    v_add_f32 v229, v229, v197
    v_add_f32 v230, v230, v198
    v_add_f32 v231, v231, v199
    v_exp_f32_e64 v16, -v224
    v_exp_f32_e64 v17, -v225
    v_exp_f32_e64 v18, -v226
    v_exp_f32_e64 v19, -v227
    v_exp_f32_e64 v20, -v228
    v_exp_f32_e64 v21, -v229
    v_exp_f32_e64 v22, -v230
    v_mfma_f32_32x32x16_bf16 v[64:79], v[104:107], v[148:151], v[64:79]
    v_exp_f32_e64 v23, -v231
    v_fma_f32 v16, v16, v10, v10
    v_fma_f32 v17, v17, v10, v10
    v_fma_f32 v18, v18, v10, v10
    v_fma_f32 v19, v19, v10, v10
    v_fma_f32 v20, v20, v10, v10
    v_fma_f32 v21, v21, v10, v10
    v_fma_f32 v22, v22, v10, v10
    v_fma_f32 v23, v23, v10, v10
    v_rcp_f32 v16, v16
    v_rcp_f32 v17, v17
    v_rcp_f32 v18, v18
    v_rcp_f32 v19, v19
    v_mfma_f32_32x32x16_bf16 v[80:95], v[108:111], v[148:151], v[80:95]
    v_rcp_f32 v20, v20
    v_rcp_f32 v21, v21
    v_rcp_f32 v22, v22
    v_rcp_f32 v23, v23
    v_mul_f32 v16, v16, v224
    v_mul_f32 v17, v17, v225
    v_mul_f32 v18, v18, v226
    v_mul_f32 v19, v19, v227
    v_mul_f32 v20, v20, v228
    v_mul_f32 v21, v21, v229
    v_mul_f32 v22, v22, v230
    v_mul_f32 v23, v23, v231
    s_waitcnt lgkmcnt(0)
    s_barrier
    v_add_u32 v48, 0x10000, v48
    v_add_u32 v49, 0x10000, v49
    ds_read_b64_tr_b16 v[96:97], v48 offset:16384
    ds_read_b64_tr_b16 v[98:99], v48 offset:17408
    ds_read_b64_tr_b16 v[100:101], v48 offset:18432
    ds_read_b64_tr_b16 v[102:103], v48 offset:19456
    s_waitcnt vmcnt(4)
    v_mfma_f32_32x32x16_bf16 v[64:79], v[112:115], v[152:155], v[64:79]
    v_add_u32 v48, 0xffff0000, v48
    v_add_u32 v49, 0xffff0000, v49
    ds_read_b64_tr_b16 v[104:105], v48 offset:16384
    ds_read_b64_tr_b16 v[106:107], v48 offset:17408
    ds_read_b64_tr_b16 v[108:109], v48 offset:18432
    ds_read_b64_tr_b16 v[110:111], v48 offset:19456
    v_mfma_f32_32x32x16_bf16 v[64:79], v[120:123], v[156:159], v[64:79]
    v_add_u32 v48, 0x10000, v48
    v_add_u32 v49, 0x10000, v49
    ds_read_b64_tr_b16 v[112:113], v49 offset:16384
    ds_read_b64_tr_b16 v[114:115], v49 offset:17408
    s_waitcnt vmcnt(2) lgkmcnt(8)
    v_mfma_f32_32x32x16_bf16 v[64:79], v[96:99], v[176:179], v[64:79]
    ds_read_b64_tr_b16 v[120:121], v49 offset:18432
    ds_read_b64_tr_b16 v[122:123], v49 offset:19456
    s_waitcnt lgkmcnt(8)
    v_mfma_f32_32x32x16_bf16 v[64:79], v[100:103], v[180:183], v[64:79]
    v_add_u32 v48, 0xffff0000, v48
    v_add_u32 v49, 0xffff0000, v49
    ds_read_b64_tr_b16 v[96:97], v49 offset:16384
    ds_read_b64_tr_b16 v[98:99], v49 offset:17408
    s_waitcnt vmcnt(0) lgkmcnt(8)
    v_mfma_f32_32x32x16_bf16 v[64:79], v[104:107], v[184:187], v[64:79]
    ds_read_b64_tr_b16 v[100:101], v49 offset:18432
    ds_read_b64_tr_b16 v[102:103], v49 offset:19456
    s_waitcnt lgkmcnt(8)
    v_mfma_f32_32x32x16_bf16 v[64:79], v[108:111], v[188:191], v[64:79]
    v_mfma_f32_32x32x16_bf16 v[80:95], v[116:119], v[152:155], v[80:95]
    v_mfma_f32_32x32x16_bf16 v[80:95], v[124:127], v[156:159], v[80:95]
    s_waitcnt lgkmcnt(6)
    v_mfma_f32_32x32x16_bf16 v[80:95], v[112:115], v[176:179], v[80:95]
    s_nop 7
    ds_write_b128 v0, v[64:67]
    s_waitcnt lgkmcnt(5)
    v_mfma_f32_32x32x16_bf16 v[80:95], v[120:123], v[180:183], v[80:95]
    ds_write_b128 v1, v[68:71]
    s_waitcnt lgkmcnt(4)
    v_mfma_f32_32x32x16_bf16 v[80:95], v[96:99], v[184:187], v[80:95]
    ds_write_b128 v2, v[72:75]
    s_waitcnt lgkmcnt(3)
    v_mfma_f32_32x32x16_bf16 v[80:95], v[100:103], v[188:191], v[80:95]
    ds_write_b128 v3, v[76:79]
    s_nop 10
    ds_write_b128 v4, v[80:83]
    ds_write_b128 v5, v[84:87]
    ds_write_b128 v6, v[88:91]
    ds_write_b128 v7, v[92:95]
    s_waitcnt lgkmcnt(0)
    s_barrier
    ds_read_b128 v[224:227], v8 offset:0
    ds_read_b128 v[228:231], v9 offset:0
    ds_read_b128 v[232:235], v8 offset:16384
    ds_read_b128 v[236:239], v9 offset:16384
    ds_read_b128 v[192:195], v8 offset:32768
    ds_read_b128 v[196:199], v9 offset:32768
    ds_read_b128 v[200:203], v8 offset:49152
    ds_read_b128 v[204:207], v9 offset:49152
    s_waitcnt lgkmcnt(5)
    v_pk_add_f32 v[224:225], v[224:225], v[232:233]
    v_pk_add_f32 v[226:227], v[226:227], v[234:235]
    s_waitcnt lgkmcnt(4)
    v_pk_add_f32 v[228:229], v[228:229], v[236:237]
    v_pk_add_f32 v[230:231], v[230:231], v[238:239]
    s_waitcnt lgkmcnt(1)
    v_pk_add_f32 v[192:193], v[192:193], v[200:201]
    v_pk_add_f32 v[194:195], v[194:195], v[202:203]
    s_waitcnt lgkmcnt(0)
    v_pk_add_f32 v[196:197], v[196:197], v[204:205]
    v_pk_add_f32 v[198:199], v[198:199], v[206:207]
    v_pk_add_f32 v[224:225], v[224:225], v[192:193]
    v_pk_add_f32 v[226:227], v[226:227], v[194:195]
    v_pk_add_f32 v[228:229], v[228:229], v[196:197]
    v_pk_add_f32 v[230:231], v[230:231], v[198:199]
    v_pk_fma_f32 v[24:25], v[224:225], v[16:17], v[24:25]
    v_pk_fma_f32 v[26:27], v[226:227], v[18:19], v[26:27]
    v_pk_fma_f32 v[28:29], v[228:229], v[20:21], v[28:29]
    v_pk_fma_f32 v[30:31], v[230:231], v[22:23], v[30:31]
    v_cvt_pk_bf16_f32 v16, v24, v25
    v_cvt_pk_bf16_f32 v17, v26, v27
    v_cvt_pk_bf16_f32 v18, v28, v29
    v_cvt_pk_bf16_f32 v19, v30, v31
    buffer_store_dwordx4 v[16:19], v56, s[76:79], s80 offen sc1
    s_endpgm
L_mlp:
    s_mul_i32 s72, s52, 448
    s_and_b32 s70, s52, 1
    s_lshl_b32 s71, s70, 6
    s_add_u32 s71, s71, s72
    s_cmp_eq_u32 s70, 0
    s_cselect_b32 s67, 384, 0
    s_add_u32 s67, s67, s72
    s_mov_b32 s64, s71
    s_add_u32 s65, s71, 128
    s_lshl_b32 s66, s52, 7
    s_waitcnt lgkmcnt(0)
    s_mov_b32 s24, s4
    s_mov_b32 s25, s5
    s_mov_b32 s26, 0x200000
    s_mov_b32 s27, 0x20000
    s_mov_b32 s36, s12
    s_mov_b32 s37, s13
    s_mov_b32 s38, 0x1c0000
    s_mov_b32 s39, 0x20000
    s_add_u32 m0, s53, 0
    s_add_u32 s68, s56, 128
    buffer_load_dwordx4 v44, s[24:27], s56 offen lds
    buffer_load_dwordx4 v45, s[24:27], s56 offen offset:1024 lds
    s_add_u32 m0, s53, 16384
    s_nop 0
    buffer_load_dwordx4 v44, s[24:27], s68 offen lds
    buffer_load_dwordx4 v45, s[24:27], s68 offen offset:1024 lds
    s_add_u32 m0, s53, 49152
    s_add_u32 s68, s57, 128
    buffer_load_dwordx4 v44, s[24:27], s57 offen lds
    buffer_load_dwordx4 v45, s[24:27], s57 offen offset:1024 lds
    s_add_u32 m0, s53, 65536
    s_nop 0
    buffer_load_dwordx4 v44, s[24:27], s68 offen lds
    buffer_load_dwordx4 v45, s[24:27], s68 offen offset:1024 lds
    s_and_b32 s49, s48, 3
    s_lshr_b32 s50, s48, 2
    v_and_b32 v3, 31, v2
    v_lshrrev_b32 v4, 5, v2
    v_bfe_u32 v5, v2, 2, 2
    v_and_b32 v6, 3, v2
    v_bfe_u32 v7, v2, 4, 1
    s_lshl_b32 s70, s49, 5
    v_add_u32 v8, s70, v3
    v_bfe_u32 v9, v8, 1, 3
    v_xor_b32 v9, v9, v4
    v_lshlrev_b32 v9, 4, v9
    v_lshl_add_u32 v9, v8, 7, v9
    s_lshl_b32 s71, s50, 1
    s_xor_b32 s71, s71, s49
    s_and_b32 s72, s71, 1
    s_lshl_b32 s72, s72, 6
    s_lshr_b32 s73, s71, 1
    s_lshl_b32 s73, s73, 14
    s_or_b32 s72, s72, s73
    v_xor_b32 v80, s72, v9
    v_xor_b32 v81, 0x20, v80
    v_xor_b32 v82, 0x40, v80
    v_xor_b32 v83, 0x60, v80
    v_xor_b32 v84, 0x4000, v80
    v_xor_b32 v85, 0x4020, v80
    v_xor_b32 v86, 0x4040, v80
    v_xor_b32 v87, 0x4060, v80
    v_lshl_add_u32 v10, v4, 3, v5
    v_lshlrev_b32 v11, 5, v7
    v_lshl_add_u32 v11, v6, 3, v11
    v_lshrrev_b32 v12, 1, v5
    v_xor_b32 v12, s50, v12
    v_lshl_add_u32 v12, v12, 6, v11
    v_lshl_add_u32 v12, v10, 7, v12
    s_lshl_b32 s73, s71, 12
    v_add_u32 v48, s73, v12
    v_xor_b32 v49, 0x1000, v48
    v_xor_b32 v50, 0x2000, v48
    v_xor_b32 v51, 0x3000, v48
    v_bfe_u32 v13, v2, 2, 1
    v_xor_b32 v13, v13, v7
    v_add_u32 v13, -1, v13
    v_and_b32 v56, 0x3f803f80, v13
    v_mov_b32 v57, v56
    v_mov_b32 v58, v56
    v_mov_b32 v59, v56
    v_mov_b32 v52, 0x3f803f80
    v_mov_b32 v88, 0
    v_mov_b32 v89, 0
    v_mov_b32 v90, 0
    v_mov_b32 v91, 0
    v_mov_b32 v92, 0
    v_mov_b32 v93, 0
    v_mov_b32 v94, 0
    v_mov_b32 v95, 0
    s_mov_b32 s28, s6
    s_mov_b32 s29, s7
    s_mov_b32 s30, 0x180000
    s_mov_b32 s31, 0x20000
    s_mul_i32 s4, s60, 3072
    s_add_u32 s4, s4, s66
    s_mul_i32 s60, s60, 3584
    s_add_u32 s60, s60, s64
    s_mul_i32 s5, s61, 3072
    s_add_u32 s5, s5, s66
    s_mul_i32 s61, s61, 3584
    s_add_u32 s61, s61, s64
    s_mul_i32 s6, s62, 3072
    s_add_u32 s6, s6, s66
    s_mul_i32 s62, s62, 3584
    s_add_u32 s62, s62, s64
    s_mul_i32 s7, s63, 3072
    s_add_u32 s7, s7, s66
    s_mul_i32 s63, s63, 3584
    s_add_u32 s63, s63, s64
    s_lshl_b32 s54, s48, 10
    s_lshl_b32 s73, s50, 9
    s_add_u32 s73, s73, 147456
    v_lshl_add_u32 v39, v3, 2, s73
    v_lshl_add_u32 v40, s49, 7, v39
    s_mul_i32 s73, s49, 147456
    s_lshl_b32 s72, s50, 11
    s_add_u32 s73, s73, s72
    v_add_u32 v42, s73, v33
    s_mul_i32 s55, s51, 589824
    v_lshlrev_b32 v54, 3, v8
    v_add_u32 v54, 148480, v54
    v_lshl_add_u32 v55, v4, 10, v54
    v_lshl_add_u32 v55, s50, 11, v55
    v_add_u32 v53, -1, v4
    s_lshl_b32 s70, s52, 11
    v_lshl_add_u32 v13, v0, 2, s70
    s_lshl_b32 s69, s48, 8
    s_add_u32 s69, s69, 153600
    v_lshl_add_u32 v14, v4, 2, v5
    v_lshlrev_b32 v14, 5, v14
    v_lshl_add_u32 v14, v6, 3, v14
    v_lshl_add_u32 v14, v7, 9, v14
    s_lshl_b32 s70, s50, 10
    s_add_u32 s70, s70, 153600
    v_add_u32 v37, s70, v14
    s_lshl_b32 s71, s50, 11
    v_lshrrev_b32 v12, 2, v0
    v_mul_u32_u24 v12, 3584, v12
    v_lshl_add_u32 v43, v6, 4, v12
    s_mov_b32 s32, s22
    s_mov_b32 s33, s23
    s_mov_b32 s34, 0xa20000
    s_mov_b32 s35, 0x20000
    s_mov_b32 s40, s16
    s_mov_b32 s41, s17
    s_mov_b32 s42, 0x1c0000
    s_mov_b32 s43, 0x20000
    s_mov_b32 s44, s10
    s_mov_b32 s45, s11
    s_mov_b32 s46, 0x80000
    s_mov_b32 s47, 0x20000
    s_and_b32 s12, s77, 3
    s_lshl_b32 s10, s76, 2
    s_add_u32 s10, s10, s12
    s_lshr_b32 s11, s77, 2
    s_mov_b32 s76, s18
    s_mov_b32 s77, s19
    s_mov_b32 s78, 0x200000
    s_mov_b32 s79, 0x20000
    s_lshl_b32 s12, s10, 1
    s_add_u32 s12, s12, s50
    s_mul_i32 s12, s12, 147456
    s_and_b32 s13, s48, 1
    s_lshl_b32 s13, s13, 11
    s_add_u32 s12, s12, s13
    s_bfe_u32 s13, s48, 0x10001
    s_mul_i32 s70, s13, 16384
    s_add_u32 s70, s70, s12
    s_mul_i32 s71, s13, 28672
    s_add_u32 s71, s71, s12
    s_mul_i32 s72, s13, 4096
    s_add_u32 s72, s72, s12
    s_lshl_b32 s12, s11, 7
    s_mul_i32 s73, s50, 262144
    s_add_u32 s73, s73, s12
    s_mul_i32 s74, s50, 458752
    s_add_u32 s74, s74, s12
    s_mul_i32 s75, s50, 65536
    s_add_u32 s75, s75, s12
    s_lshl3_add_u32 s80, s10, s48
    s_lshl_b32 s80, s80, 13
    s_add_u32 s80, s80, s12
    s_lshr_b32 s81, s10, 1
    s_lshl_b32 s81, s81, 11
    s_add_u32 s81, s81, 10551296
    s_lshl_b32 s17, s52, 7
    s_add_u32 s17, s17, 10551296
    s_lshl_b32 s16, s51, 11
    s_add_u32 s16, s16, s17
    s_add_u32 s16, s16, 1024
    s_add_u32 s72, s72, 114688
    s_sub_u32 s19, s67, s64
    s_add_u32 m0, s53, 32768
    s_add_u32 s68, s60, 27648
    buffer_load_dwordx4 v47, s[36:39], s60 offen lds
    buffer_load_dwordx4 v47, s[36:39], s68 offen offset:1024 lds
    s_waitcnt vmcnt(2)
    s_barrier
    s_add_u32 m0, s53, 81920
    s_add_u32 s68, s61, 27648
    buffer_load_dwordx4 v47, s[36:39], s61 offen lds
    ds_read_b128 v[128:131], v80 offset:0
    ds_read_b128 v[132:135], v81 offset:0
    ds_read_b128 v[136:139], v82 offset:0
    ds_read_b128 v[140:143], v83 offset:0
    ds_read_b128 v[160:163], v80 offset:49152
    ds_read_b128 v[164:167], v81 offset:49152
    ds_read_b128 v[168:171], v82 offset:49152
    ds_read_b128 v[172:175], v83 offset:49152
    buffer_load_dwordx4 v47, s[36:39], s68 offen offset:1024 lds
    ds_read_b128 v[144:147], v84 offset:0
    ds_read_b128 v[148:151], v85 offset:0
    ds_read_b128 v[152:155], v86 offset:0
    ds_read_b128 v[156:159], v87 offset:0
    ds_read_b128 v[176:179], v84 offset:49152
    ds_read_b128 v[180:183], v85 offset:49152
    ds_read_b128 v[184:187], v86 offset:49152
    ds_read_b128 v[188:191], v87 offset:49152
    s_waitcnt lgkmcnt(15)
    v_dot2_f32_bf16 v88, v128, v52, v88
    v_dot2_f32_bf16 v89, v128, v128, v89
    v_dot2_f32_bf16 v90, v129, v52, v90
    v_dot2_f32_bf16 v91, v129, v129, v91
    v_dot2_f32_bf16 v92, v130, v52, v92
    v_dot2_f32_bf16 v93, v130, v130, v93
    v_dot2_f32_bf16 v94, v131, v52, v94
    v_dot2_f32_bf16 v95, v131, v131, v95
    s_waitcnt lgkmcnt(9)
    v_dot2_f32_bf16 v88, v132, v52, v88
    v_dot2_f32_bf16 v89, v132, v132, v89
    v_dot2_f32_bf16 v90, v133, v52, v90
    s_add_u32 m0, s53, 98304
    s_add_u32 s68, s58, 128
    buffer_load_dwordx4 v44, s[24:27], s58 offen lds
    v_dot2_f32_bf16 v91, v133, v133, v91
    v_dot2_f32_bf16 v92, v134, v52, v92
    v_dot2_f32_bf16 v93, v134, v134, v93
    v_dot2_f32_bf16 v94, v135, v52, v94
    v_dot2_f32_bf16 v95, v135, v135, v95
    v_dot2_f32_bf16 v88, v136, v52, v88
    v_dot2_f32_bf16 v89, v136, v136, v89
    v_dot2_f32_bf16 v90, v137, v52, v90
    v_dot2_f32_bf16 v91, v137, v137, v91
    v_dot2_f32_bf16 v92, v138, v52, v92
    buffer_load_dwordx4 v45, s[24:27], s58 offen offset:1024 lds
    v_dot2_f32_bf16 v93, v138, v138, v93
    v_dot2_f32_bf16 v94, v139, v52, v94
    v_dot2_f32_bf16 v95, v139, v139, v95
    v_dot2_f32_bf16 v88, v140, v52, v88
    v_dot2_f32_bf16 v89, v140, v140, v89
    v_dot2_f32_bf16 v90, v141, v52, v90
    v_dot2_f32_bf16 v91, v141, v141, v91
    v_dot2_f32_bf16 v92, v142, v52, v92
    v_dot2_f32_bf16 v93, v142, v142, v93
    v_dot2_f32_bf16 v94, v143, v52, v94
    v_dot2_f32_bf16 v95, v143, v143, v95
    s_add_u32 m0, s53, 114688
    s_nop 0
    buffer_load_dwordx4 v44, s[24:27], s68 offen lds
    v_dot2_f32_bf16 v88, v160, v52, v88
    v_dot2_f32_bf16 v89, v160, v160, v89
    v_dot2_f32_bf16 v90, v161, v52, v90
    v_dot2_f32_bf16 v91, v161, v161, v91
    v_dot2_f32_bf16 v92, v162, v52, v92
    v_dot2_f32_bf16 v93, v162, v162, v93
    v_dot2_f32_bf16 v94, v163, v52, v94
    v_dot2_f32_bf16 v95, v163, v163, v95
    v_dot2_f32_bf16 v88, v164, v52, v88
    v_dot2_f32_bf16 v89, v164, v164, v89
    v_dot2_f32_bf16 v90, v165, v52, v90
    buffer_load_dwordx4 v45, s[24:27], s68 offen offset:1024 lds
    v_dot2_f32_bf16 v91, v165, v165, v91
    v_dot2_f32_bf16 v92, v166, v52, v92
    v_dot2_f32_bf16 v93, v166, v166, v93
    v_dot2_f32_bf16 v94, v167, v52, v94
    v_dot2_f32_bf16 v95, v167, v167, v95
    v_dot2_f32_bf16 v88, v168, v52, v88
    v_dot2_f32_bf16 v89, v168, v168, v89
    v_dot2_f32_bf16 v90, v169, v52, v90
    v_dot2_f32_bf16 v91, v169, v169, v91
    v_dot2_f32_bf16 v92, v170, v52, v92
    s_add_u32 m0, s53, 131072
    s_add_u32 s68, s62, 27648
    buffer_load_dwordx4 v47, s[36:39], s62 offen lds
    v_dot2_f32_bf16 v93, v170, v170, v93
    v_dot2_f32_bf16 v94, v171, v52, v94
    v_dot2_f32_bf16 v95, v171, v171, v95
    s_waitcnt lgkmcnt(0)
    v_dot2_f32_bf16 v88, v172, v52, v88
    v_dot2_f32_bf16 v89, v172, v172, v89
    v_dot2_f32_bf16 v90, v173, v52, v90
    v_dot2_f32_bf16 v91, v173, v173, v91
    v_dot2_f32_bf16 v92, v174, v52, v92
    v_dot2_f32_bf16 v93, v174, v174, v93
    v_dot2_f32_bf16 v94, v175, v52, v94
    v_dot2_f32_bf16 v95, v175, v175, v95
    buffer_load_dwordx4 v47, s[36:39], s68 offen offset:1024 lds
    s_waitcnt vmcnt(8)
    s_barrier
    ds_read_b64_tr_b16 v[96:97], v48 offset:32768
    ds_read_b64_tr_b16 v[98:99], v48 offset:33280
    ds_read_b64_tr_b16 v[100:101], v48 offset:34816
    ds_read_b64_tr_b16 v[102:103], v48 offset:35328
    ds_read_b64_tr_b16 v[104:105], v49 offset:32768
    ds_read_b64_tr_b16 v[106:107], v49 offset:33280
    ds_read_b64_tr_b16 v[108:109], v49 offset:34816
    ds_read_b64_tr_b16 v[110:111], v49 offset:35328
    ds_read_b64_tr_b16 v[112:113], v50 offset:32768
    ds_read_b64_tr_b16 v[114:115], v50 offset:33280
    ds_read_b64_tr_b16 v[116:117], v50 offset:34816
    ds_read_b64_tr_b16 v[118:119], v50 offset:35328
    ds_read_b64_tr_b16 v[120:121], v51 offset:32768
    ds_read_b64_tr_b16 v[122:123], v51 offset:33280
    ds_read_b64_tr_b16 v[124:125], v51 offset:34816
    ds_read_b64_tr_b16 v[126:127], v51 offset:35328
    s_waitcnt lgkmcnt(14)
    v_mfma_f32_32x32x16_bf16 v[64:79], v[96:99], v[128:131], 0
    v_mfma_f32_16x16x32_bf16 v[60:63], v[56:59], v[96:99], 0
    s_add_u32 m0, s53, 0
    s_add_u32 s68, s59, 128
    buffer_load_dwordx4 v44, s[24:27], s59 offen lds
    s_waitcnt lgkmcnt(12)
    v_mfma_f32_32x32x16_bf16 v[64:79], v[100:103], v[132:135], v[64:79]
    v_mfma_f32_16x16x32_bf16 v[60:63], v[56:59], v[100:103], v[60:63]
    buffer_load_dwordx4 v45, s[24:27], s59 offen offset:1024 lds
    s_waitcnt lgkmcnt(9)
    v_mfma_f32_32x32x16_bf16 v[64:79], v[104:107], v[136:139], v[64:79]
    s_add_u32 m0, s53, 16384
    s_nop 0
    buffer_load_dwordx4 v44, s[24:27], s68 offen lds
    s_waitcnt lgkmcnt(4)
    v_mfma_f32_32x32x16_bf16 v[64:79], v[108:111], v[140:143], v[64:79]
    buffer_load_dwordx4 v45, s[24:27], s68 offen offset:1024 lds
    s_waitcnt vmcnt(10) lgkmcnt(0)
    s_barrier
    v_mfma_f32_32x32x16_bf16 v[64:79], v[112:115], v[144:147], v[64:79]
    v_mov_b32 v32, 0
    global_load_dword v32, v32, s[20:21] sc1
    v_add_u32 v48, 0x10000, v48
    v_add_u32 v49, 0x10000, v49
    v_add_u32 v50, 0x10000, v50
    v_add_u32 v51, 0x10000, v51
    ds_read_b64_tr_b16 v[96:97], v48 offset:16384
    ds_read_b64_tr_b16 v[98:99], v48 offset:16896
    s_add_u32 m0, s53, 49152
    s_add_u32 s68, s63, 27648
    buffer_load_dwordx4 v47, s[36:39], s63 offen lds
    v_mfma_f32_32x32x16_bf16 v[64:79], v[116:119], v[148:151], v[64:79]
    ds_read_b64_tr_b16 v[100:101], v48 offset:18432
    ds_read_b64_tr_b16 v[102:103], v48 offset:18944
    ds_read_b64_tr_b16 v[104:105], v49 offset:16384
    ds_read_b64_tr_b16 v[106:107], v49 offset:16896
    buffer_load_dwordx4 v47, s[36:39], s68 offen offset:1024 lds
    v_mfma_f32_32x32x16_bf16 v[64:79], v[120:123], v[152:155], v[64:79]
    ds_read_b64_tr_b16 v[108:109], v49 offset:18432
    ds_read_b64_tr_b16 v[110:111], v49 offset:18944
    v_lshrrev_b32 v45, 2, v33
    v_and_b32 v45, 64, v45
    v_and_b32 v44, 0x70, v33
    v_xor_b32 v44, v44, v45
    v_lshrrev_b32 v45, 7, v33
    v_mfma_f32_32x32x16_bf16 v[64:79], v[124:127], v[156:159], v[64:79]
    ds_read_b64_tr_b16 v[112:113], v50 offset:16384
    ds_read_b64_tr_b16 v[114:115], v50 offset:16896
    ds_read_b64_tr_b16 v[116:117], v50 offset:18432
    ds_read_b64_tr_b16 v[118:119], v50 offset:18944
    s_add_u32 m0, s53, 65536
    s_add_u32 s68, s60, 128
    buffer_load_dwordx4 v47, s[36:39], s68 offen lds
    s_waitcnt lgkmcnt(8)
    v_mfma_f32_32x32x16_bf16 v[64:79], v[96:99], v[160:163], v[64:79]
    ds_read_b64_tr_b16 v[120:121], v51 offset:16384
    ds_read_b64_tr_b16 v[122:123], v51 offset:16896
    v_mfma_f32_16x16x32_bf16 v[60:63], v[56:59], v[96:99], v[60:63]
    s_add_u32 s68, s68, 27648
    buffer_load_dwordx4 v47, s[36:39], s68 offen offset:1024 lds
    v_mfma_f32_32x32x16_bf16 v[64:79], v[100:103], v[164:167], v[64:79]
    ds_read_b64_tr_b16 v[124:125], v51 offset:18432
    ds_read_b64_tr_b16 v[126:127], v51 offset:18944
    v_mfma_f32_16x16x32_bf16 v[60:63], v[56:59], v[100:103], v[60:63]
    s_waitcnt lgkmcnt(8)
    v_mfma_f32_32x32x16_bf16 v[64:79], v[104:107], v[168:171], v[64:79]
    v_bfe_u32 v35, v33, 3, 6
    v_add_u32 v35, s64, v35
    v_lshl_add_u32 v35, s50, 6, v35
    global_load_ushort v35, v35, s[14:15]
    v_lshl_add_u32 v44, v45, 10, v44
    v_mfma_f32_32x32x16_bf16 v[64:79], v[108:111], v[172:175], v[64:79]
    s_lshl_b32 s12, s49, 14
    v_add_u32 v44, s12, v44
    v_add_u32 v45, 7168, v44
    s_waitcnt vmcnt(10) lgkmcnt(0)
    s_barrier
    v_mfma_f32_32x32x16_bf16 v[64:79], v[112:115], v[176:179], v[64:79]
    s_mov_b32 m0, s69
    s_nop 0
    global_load_lds_dword v13, s[8:9]
    v_add_u32 v48, 0x8000, v48
    v_add_u32 v49, 0x8000, v49
    v_add_u32 v50, 0x8000, v50
    v_add_u32 v51, 0x8000, v51
    v_add_u32 v80, 0x10000, v80
    v_add_u32 v81, 0x10000, v81
    v_add_u32 v82, 0x10000, v82
    v_add_u32 v83, 0x10000, v83
    v_add_u32 v84, 0x10000, v84
    v_add_u32 v85, 0x10000, v85
    v_add_u32 v86, 0x10000, v86
    v_add_u32 v87, 0x10000, v87
    ds_read_b64_tr_b16 v[96:97], v48 offset:32768
    ds_read_b64_tr_b16 v[98:99], v48 offset:33280
    ds_read_b128 v[192:195], v80 offset:32768
    ds_read_b64_tr_b16 v[100:101], v48 offset:34816
    ds_read_b64_tr_b16 v[102:103], v48 offset:35328
    ds_read_b128 v[196:199], v81 offset:32768
    s_add_u32 m0, s53, 32768
    s_add_u32 s68, s61, 128
    buffer_load_dwordx4 v47, s[36:39], s68 offen lds
    v_mfma_f32_32x32x16_bf16 v[64:79], v[116:119], v[180:183], v[64:79]
    ds_read_b64_tr_b16 v[104:105], v49 offset:32768
    ds_read_b64_tr_b16 v[106:107], v49 offset:33280
    ds_read_b128 v[200:203], v82 offset:32768
    ds_read_b64_tr_b16 v[108:109], v49 offset:34816
    ds_read_b64_tr_b16 v[110:111], v49 offset:35328
    ds_read_b128 v[204:207], v83 offset:32768
    s_add_u32 s68, s68, 27648
    buffer_load_dwordx4 v47, s[36:39], s68 offen offset:1024 lds
    v_mfma_f32_32x32x16_bf16 v[64:79], v[120:123], v[184:187], v[64:79]
    ds_read_b64_tr_b16 v[112:113], v50 offset:32768
    ds_read_b64_tr_b16 v[114:115], v50 offset:33280
    ds_read_b128 v[208:211], v84 offset:32768
    ds_read_b64_tr_b16 v[116:117], v50 offset:34816
    ds_read_b64_tr_b16 v[118:119], v50 offset:35328
    ds_read_b128 v[212:215], v85 offset:32768
    s_add_u32 m0, s53, 81920
    s_add_u32 s68, s62, 128
    buffer_load_dwordx4 v47, s[36:39], s68 offen lds
    v_mfma_f32_32x32x16_bf16 v[64:79], v[124:127], v[188:191], v[64:79]
    ds_read_b64_tr_b16 v[120:121], v51 offset:32768
    ds_read_b64_tr_b16 v[122:123], v51 offset:33280
    ds_read_b128 v[216:219], v86 offset:32768
    s_waitcnt lgkmcnt(12)
    v_dot2_f32_bf16 v88, v192, v52, v88
    v_dot2_f32_bf16 v89, v192, v192, v89
    v_dot2_f32_bf16 v90, v193, v52, v90
    v_dot2_f32_bf16 v91, v193, v193, v91
    v_dot2_f32_bf16 v92, v194, v52, v92
    v_dot2_f32_bf16 v93, v194, v194, v93
    v_dot2_f32_bf16 v94, v195, v52, v94
    v_dot2_f32_bf16 v95, v195, v195, v95
    v_dot2_f32_bf16 v88, v196, v52, v88
    v_dot2_f32_bf16 v89, v196, v196, v89
    v_dot2_f32_bf16 v90, v197, v52, v90
    v_dot2_f32_bf16 v91, v197, v197, v91
    v_dot2_f32_bf16 v92, v198, v52, v92
    v_dot2_f32_bf16 v93, v198, v198, v93
    v_dot2_f32_bf16 v94, v199, v52, v94
    v_dot2_f32_bf16 v95, v199, v199, v95
    v_dot2_f32_bf16 v88, v200, v52, v88
    v_dot2_f32_bf16 v89, v200, v200, v89
    v_dot2_f32_bf16 v90, v201, v52, v90
    v_dot2_f32_bf16 v91, v201, v201, v91
    v_dot2_f32_bf16 v92, v202, v52, v92
    v_dot2_f32_bf16 v93, v202, v202, v93
    v_dot2_f32_bf16 v94, v203, v52, v94
    v_dot2_f32_bf16 v95, v203, v203, v95
    s_waitcnt lgkmcnt(0)
    v_dot2_f32_bf16 v88, v204, v52, v88
    v_dot2_f32_bf16 v89, v204, v204, v89
    v_dot2_f32_bf16 v90, v205, v52, v90
    v_dot2_f32_bf16 v91, v205, v205, v91
    v_dot2_f32_bf16 v92, v206, v52, v92
    v_dot2_f32_bf16 v93, v206, v206, v93
    v_dot2_f32_bf16 v94, v207, v52, v94
    v_dot2_f32_bf16 v95, v207, v207, v95
    v_mfma_f32_32x32x16_bf16 v[64:79], v[96:99], v[192:195], v[64:79]
    ds_read_b64_tr_b16 v[124:125], v51 offset:34816
    ds_read_b64_tr_b16 v[126:127], v51 offset:35328
    ds_read_b128 v[220:223], v87 offset:32768
    v_mfma_f32_16x16x32_bf16 v[60:63], v[56:59], v[96:99], v[60:63]
    s_add_u32 s68, s68, 27648
    buffer_load_dwordx4 v47, s[36:39], s68 offen offset:1024 lds
    v_mfma_f32_32x32x16_bf16 v[64:79], v[100:103], v[196:199], v[64:79]
    v_mfma_f32_16x16x32_bf16 v[60:63], v[56:59], v[100:103], v[60:63]
    v_bfe_u32 v38, v33, 3, 6
    v_add_u32 v38, s67, v38
    global_load_ushort v38, v38, s[14:15]
    v_mfma_f32_32x32x16_bf16 v[64:79], v[104:107], v[200:203], v[64:79]
    v_bfe_u32 v36, v33, 3, 6
    v_add_u32 v36, s65, v36
    v_lshl_add_u32 v36, s50, 6, v36
    global_load_ushort v36, v36, s[14:15]
    v_mfma_f32_32x32x16_bf16 v[64:79], v[108:111], v[204:207], v[64:79]
    s_waitcnt vmcnt(10) lgkmcnt(0)
    s_barrier
    v_mfma_f32_32x32x16_bf16 v[64:79], v[112:115], v[208:211], v[64:79]
    v_add_u32 v48, 0xfffe8000, v48
    v_add_u32 v49, 0xfffe8000, v49
    v_add_u32 v50, 0xfffe8000, v50
    v_add_u32 v51, 0xfffe8000, v51
    v_add_u32 v80, 0xffff0000, v80
    v_add_u32 v81, 0xffff0000, v81
    v_add_u32 v82, 0xffff0000, v82
    v_add_u32 v83, 0xffff0000, v83
    v_add_u32 v84, 0xffff0000, v84
    v_add_u32 v85, 0xffff0000, v85
    v_add_u32 v86, 0xffff0000, v86
    v_add_u32 v87, 0xffff0000, v87
    ds_read_b64_tr_b16 v[96:97], v48 offset:49152
    ds_read_b64_tr_b16 v[98:99], v48 offset:49664
    ds_read_b128 v[224:227], v80 offset:0
    ds_read_b64_tr_b16 v[100:101], v48 offset:51200
    ds_read_b64_tr_b16 v[102:103], v48 offset:51712
    ds_read_b128 v[228:231], v81 offset:0
    s_add_u32 m0, s53, 98304
    s_add_u32 s68, s63, 128
    buffer_load_dwordx4 v47, s[36:39], s68 offen lds
    v_mfma_f32_32x32x16_bf16 v[64:79], v[116:119], v[212:215], v[64:79]
    ds_read_b64_tr_b16 v[104:105], v49 offset:49152
    ds_read_b64_tr_b16 v[106:107], v49 offset:49664
    ds_read_b128 v[232:235], v82 offset:0
    ds_read_b64_tr_b16 v[108:109], v49 offset:51200
    ds_read_b64_tr_b16 v[110:111], v49 offset:51712
    ds_read_b128 v[236:239], v83 offset:0
    v_mfma_f32_32x32x16_bf16 v[64:79], v[120:123], v[216:219], v[64:79]
    ds_read_b64_tr_b16 v[112:113], v50 offset:49152
    ds_read_b64_tr_b16 v[114:115], v50 offset:49664
    ds_read_b128 v[240:243], v84 offset:0
    ds_read_b64_tr_b16 v[116:117], v50 offset:51200
    ds_read_b64_tr_b16 v[118:119], v50 offset:51712
    ds_read_b128 v[244:247], v85 offset:0
    s_add_u32 s68, s68, 27648
    buffer_load_dwordx4 v47, s[36:39], s68 offen offset:1024 lds
    v_mfma_f32_32x32x16_bf16 v[64:79], v[124:127], v[220:223], v[64:79]
    ds_read_b64_tr_b16 v[120:121], v51 offset:49152
    ds_read_b64_tr_b16 v[122:123], v51 offset:49664
    ds_read_b128 v[248:251], v86 offset:0
    s_waitcnt lgkmcnt(15)
    v_dot2_f32_bf16 v88, v224, v52, v88
    v_dot2_f32_bf16 v89, v224, v224, v89
    v_dot2_f32_bf16 v90, v225, v52, v90
    v_dot2_f32_bf16 v91, v225, v225, v91
    v_dot2_f32_bf16 v92, v226, v52, v92
    v_dot2_f32_bf16 v93, v226, v226, v93
    v_dot2_f32_bf16 v94, v227, v52, v94
    v_dot2_f32_bf16 v95, v227, v227, v95
    v_dot2_f32_bf16 v88, v228, v52, v88
    v_dot2_f32_bf16 v89, v228, v228, v89
    v_dot2_f32_bf16 v90, v229, v52, v90
    v_dot2_f32_bf16 v91, v229, v229, v91
    v_dot2_f32_bf16 v92, v230, v52, v92
    v_dot2_f32_bf16 v93, v230, v230, v93
    v_dot2_f32_bf16 v94, v231, v52, v94
    v_dot2_f32_bf16 v95, v231, v231, v95
    s_waitcnt lgkmcnt(2)
    v_dot2_f32_bf16 v88, v232, v52, v88
    v_dot2_f32_bf16 v89, v232, v232, v89
    v_dot2_f32_bf16 v90, v233, v52, v90
    v_dot2_f32_bf16 v91, v233, v233, v91
    v_dot2_f32_bf16 v92, v234, v52, v92
    v_dot2_f32_bf16 v93, v234, v234, v93
    v_dot2_f32_bf16 v94, v235, v52, v94
    v_dot2_f32_bf16 v95, v235, v235, v95
    v_dot2_f32_bf16 v88, v236, v52, v88
    v_dot2_f32_bf16 v89, v236, v236, v89
    v_dot2_f32_bf16 v90, v237, v52, v90
    v_dot2_f32_bf16 v91, v237, v237, v91
    v_dot2_f32_bf16 v92, v238, v52, v92
    v_dot2_f32_bf16 v93, v238, v238, v93
    v_dot2_f32_bf16 v94, v239, v52, v94
    v_dot2_f32_bf16 v95, v239, v239, v95
    v_add_f32 v88, v88, v92
    v_add_f32 v89, v89, v93
    v_add_f32 v90, v90, v94
    v_add_f32 v91, v91, v95
    v_add_f32 v88, v88, v90
    v_add_f32 v89, v89, v91
    ds_write_b64 v55, v[88:89]
    v_mfma_f32_32x32x16_bf16 v[64:79], v[96:99], v[224:227], v[64:79]
    ds_read_b64_tr_b16 v[124:125], v51 offset:51200
    ds_read_b64_tr_b16 v[126:127], v51 offset:51712
    ds_read_b128 v[252:255], v87 offset:0
    v_mfma_f32_16x16x32_bf16 v[60:63], v[56:59], v[96:99], v[60:63]
    s_add_u32 m0, s53, 114688
    s_add_u32 s68, s4, 23552
    buffer_load_dwordx4 v46, s[28:31], s4 offen lds
    v_mfma_f32_32x32x16_bf16 v[64:79], v[100:103], v[228:231], v[64:79]
    v_mfma_f32_16x16x32_bf16 v[60:63], v[56:59], v[100:103], v[60:63]
    v_mfma_f32_32x32x16_bf16 v[64:79], v[104:107], v[232:235], v[64:79]
    buffer_load_dwordx4 v46, s[28:31], s68 offen offset:1024 lds
    v_mfma_f32_32x32x16_bf16 v[64:79], v[108:111], v[236:239], v[64:79]
    s_nop 4
    ds_write_b32 v40, v60
    s_cmp_lg_u32 s48, 0
    s_cbranch_scc1 L_po28
    s_mov_b32 s11, 0
L_pc27:
    v_readfirstlane_b32 s3, v32
    s_nop 2
    s_cmp_lg_u32 s3, 0
    s_cbranch_scc1 L_po28
    s_add_u32 s11, s11, 1
    s_cmp_ge_u32 s11, 0x40000
    s_cbranch_scc1 L_po28
    s_sleep 1
    v_mov_b32 v32, 0
    global_load_dword v32, v32, s[20:21] sc1
    s_waitcnt vmcnt(0)
    s_branch L_pc27
L_po28:
    s_waitcnt vmcnt(10) lgkmcnt(0)
    s_barrier
    v_mfma_f32_32x32x16_bf16 v[64:79], v[112:115], v[240:243], v[64:79]
    ds_read2st64_b64 v[16:19], v54 offset0:0 offset1:2
    ds_read2st64_b64 v[20:23], v54 offset0:4 offset1:6
    ds_read2_b32 v[8:9], v39 offset0:0 offset1:32
    ds_read2_b32 v[10:11], v39 offset0:64 offset1:96
    v_add_u32 v48, 0x10000, v48
    v_add_u32 v49, 0x10000, v49
    v_add_u32 v50, 0x10000, v50
    v_add_u32 v51, 0x10000, v51
    ds_read_b64_tr_b16 v[96:97], v48 offset:0
    ds_read_b64_tr_b16 v[98:99], v48 offset:512
    s_add_u32 m0, s53, 0
    s_add_u32 s68, s5, 23552
    buffer_load_dwordx4 v46, s[28:31], s5 offen lds
    v_mfma_f32_32x32x16_bf16 v[64:79], v[116:119], v[244:247], v[64:79]
    ds_read_b64_tr_b16 v[100:101], v48 offset:2048
    ds_read_b64_tr_b16 v[102:103], v48 offset:2560
    ds_read_b64_tr_b16 v[104:105], v49 offset:0
    ds_read_b64_tr_b16 v[106:107], v49 offset:512
    s_waitcnt lgkmcnt(9)
    v_add_f32 v16, v16, v18
    v_add_f32 v17, v17, v19
    s_waitcnt lgkmcnt(8)
    v_add_f32 v20, v20, v22
    v_add_f32 v21, v21, v23
    v_add_f32 v16, v16, v20
    v_add_f32 v17, v17, v21
    v_mul_f32 v16, 0xbb000000, v16
    v_mul_f32 v18, v16, v16
    v_mul_f32 v17, 0x3b000000, v17
    v_sub_f32 v17, v17, v18
    v_max_f32 v17, 0, v17
    v_add_f32 v17, 0x3727c5ac, v17
    v_mfma_f32_32x32x16_bf16 v[64:79], v[120:123], v[248:251], v[64:79]
    ds_read_b64_tr_b16 v[108:109], v49 offset:2048
    ds_read_b64_tr_b16 v[110:111], v49 offset:2560
    v_rsq_f32 v18, v17
    v_cvt_pk_bf16_f32 v20, v16, v16
    v_mul_f32 v19, v17, v18
    v_and_b32 v21, 0xffff0000, v20
    v_sub_f32 v21, v16, v21
    v_cvt_pk_bf16_f32 v22, v21, v19
    v_and_b32 v23, 0xffff0000, v22
    v_sub_f32 v23, v19, v23
    v_cvt_pk_bf16_f32 v23, v23, 0
    v_mul_f32 v41, 0x3fb8aa3b, v18
    v_and_b32 v52, v20, v53
    v_and_b32 v54, v23, v53
    buffer_load_dwordx4 v46, s[28:31], s68 offen offset:1024 lds
    v_mfma_f32_32x32x16_bf16 v[64:79], v[124:127], v[252:255], v[64:79]
    ds_read_b64_tr_b16 v[112:113], v50 offset:0
    ds_read_b64_tr_b16 v[114:115], v50 offset:512
    ds_read_b64_tr_b16 v[116:117], v50 offset:2048
    ds_read_b64_tr_b16 v[118:119], v50 offset:2560
    v_and_b32 v53, v22, v53
    v_mov_b32 v55, 0
    v_lshlrev_b32 v12, 16, v35
    v_mov_b32 v2, v35
    v_mov_b32 v3, 0
    s_waitcnt lgkmcnt(4)
    v_add_f32 v8, v8, v9
    v_add_f32 v10, v10, v11
    v_add_f32 v8, v8, v10
    v_cvt_pk_bf16_f32 v9, v8, v8
    v_cvt_pk_bf16_f32 v1, v8, v12
    v_and_b32 v9, 0xffff0000, v9
    v_sub_f32 v9, v8, v9
    v_cvt_pk_bf16_f32 v0, v8, v9
    s_nop 1
    v_mfma_f32_32x32x16_bf16 v[64:79], v[0:3], v[52:55], v[64:79]
    s_add_u32 m0, s53, 16384
    s_add_u32 s68, s6, 23552
    buffer_load_dwordx4 v46, s[28:31], s6 offen lds
    v_mfma_f32_32x32x16_bf16 v[80:95], v[96:99], v[128:131], 0
    ds_read_b64_tr_b16 v[120:121], v51 offset:0
    ds_read_b64_tr_b16 v[122:123], v51 offset:512
    v_mfma_f32_16x16x32_bf16 v[60:63], v[56:59], v[96:99], 0
    v_mfma_f32_32x32x16_bf16 v[80:95], v[100:103], v[132:135], v[80:95]
    ds_read_b64_tr_b16 v[124:125], v51 offset:2048
    ds_read_b64_tr_b16 v[126:127], v51 offset:2560
    v_mfma_f32_16x16x32_bf16 v[60:63], v[56:59], v[100:103], v[60:63]
    buffer_load_dwordx4 v46, s[28:31], s68 offen offset:1024 lds
    s_lshl_b32 s69, s64, 5
    s_add_u32 s69, s69, s55
    v_mfma_f32_32x32x16_bf16 v[80:95], v[104:107], v[136:139], v[80:95]
    v_mul_f32 v64, v64, v41
    v_exp_f32 v24, v64
    v_mul_f32 v65, v65, v41
    v_fma_f32 v16, v24, -0.5, -1.0
    v_exp_f32 v25, v65
    v_mul_f32 v66, v66, v41
    v_fma_f32 v24, v24, v16, -1.0
    v_mfma_f32_32x32x16_bf16 v[80:95], v[108:111], v[140:143], v[80:95]
    v_fma_f32 v17, v25, -0.5, -1.0
    v_exp_f32 v26, v66
    v_mul_f32 v67, v67, v41
    v_rcp_f32 v24, v24
    s_waitcnt vmcnt(12) lgkmcnt(0)
    s_barrier
    v_mfma_f32_32x32x16_bf16 v[80:95], v[112:115], v[144:147], v[80:95]
    v_add_u32 v48, 0xffff0000, v48
    v_add_u32 v49, 0xffff0000, v49
    v_add_u32 v50, 0xffff0000, v50
    v_add_u32 v51, 0xffff0000, v51
    ds_read_b64_tr_b16 v[96:97], v48 offset:32768
    ds_read_b64_tr_b16 v[98:99], v48 offset:33280
    s_add_u32 m0, s53, 49152
    s_add_u32 s68, s7, 23552
    buffer_load_dwordx4 v46, s[28:31], s7 offen lds
    v_fma_f32 v25, v25, v17, -1.0
    v_mfma_f32_32x32x16_bf16 v[80:95], v[116:119], v[148:151], v[80:95]
    ds_read_b64_tr_b16 v[100:101], v48 offset:34816
    ds_read_b64_tr_b16 v[102:103], v48 offset:35328
    ds_read_b64_tr_b16 v[104:105], v49 offset:32768
    ds_read_b64_tr_b16 v[106:107], v49 offset:33280
    v_fma_f32 v18, v26, -0.5, -1.0
    v_exp_f32 v27, v67
    v_mul_f32 v68, v68, v41
    v_fma_f32 v64, v64, v24, v64
    v_rcp_f32 v25, v25
    v_mfma_f32_32x32x16_bf16 v[80:95], v[120:123], v[152:155], v[80:95]
    ds_read_b64_tr_b16 v[108:109], v49 offset:34816
    ds_read_b64_tr_b16 v[110:111], v49 offset:35328
    buffer_load_dwordx4 v46, s[28:31], s68 offen offset:1024 lds
    v_fma_f32 v26, v26, v18, -1.0
    v_fma_f32 v19, v27, -0.5, -1.0
    v_exp_f32 v28, v68
    v_mul_f32 v69, v69, v41
    v_fma_f32 v65, v65, v25, v65
    v_mfma_f32_32x32x16_bf16 v[80:95], v[124:127], v[156:159], v[80:95]
    ds_read_b64_tr_b16 v[112:113], v50 offset:32768
    ds_read_b64_tr_b16 v[114:115], v50 offset:33280
    ds_read_b64_tr_b16 v[116:117], v50 offset:34816
    ds_read_b64_tr_b16 v[118:119], v50 offset:35328
    v_rcp_f32 v26, v26
    v_fma_f32 v27, v27, v19, -1.0
    v_fma_f32 v16, v28, -0.5, -1.0
    v_exp_f32 v29, v69
    v_mul_f32 v70, v70, v41
    v_fma_f32 v66, v66, v26, v66
    s_waitcnt lgkmcnt(6)
    v_mfma_f32_32x32x16_bf16 v[80:95], v[96:99], v[160:163], v[80:95]
    ds_read_b64_tr_b16 v[120:121], v51 offset:32768
    ds_read_b64_tr_b16 v[122:123], v51 offset:33280
    v_mfma_f32_16x16x32_bf16 v[60:63], v[56:59], v[96:99], v[60:63]
    s_add_u32 m0, s54, 65536
    s_add_u32 s68, s60, s19
    buffer_load_dwordx4 v43, s[36:39], s68 offen lds
    v_rcp_f32 v27, v27
    v_mfma_f32_32x32x16_bf16 v[80:95], v[100:103], v[164:167], v[80:95]
    ds_read_b64_tr_b16 v[124:125], v51 offset:34816
    ds_read_b64_tr_b16 v[126:127], v51 offset:35328
    v_mfma_f32_16x16x32_bf16 v[60:63], v[56:59], v[100:103], v[60:63]
    v_fma_f32 v28, v28, v16, -1.0
    v_fma_f32 v17, v29, -0.5, -1.0
    v_exp_f32 v30, v70
    v_mfma_f32_32x32x16_bf16 v[80:95], v[104:107], v[168:171], v[80:95]
    s_add_u32 m0, s54, 73728
    s_add_u32 s68, s61, s19
    buffer_load_dwordx4 v43, s[36:39], s68 offen lds
    v_mul_f32 v71, v71, v41
    v_fma_f32 v67, v67, v27, v67
    v_rcp_f32 v28, v28
    v_fma_f32 v29, v29, v17, -1.0
    v_fma_f32 v18, v30, -0.5, -1.0
    s_waitcnt lgkmcnt(2)
    v_mfma_f32_32x32x16_bf16 v[80:95], v[108:111], v[172:175], v[80:95]
    v_exp_f32 v31, v71
    v_fma_f32 v68, v68, v28, v68
    v_rcp_f32 v29, v29
    v_fma_f32 v30, v30, v18, -1.0
    v_fma_f32 v19, v31, -0.5, -1.0
    v_fma_f32 v69, v69, v29, v69
    s_waitcnt vmcnt(14) lgkmcnt(0)
    s_barrier
    v_mfma_f32_32x32x16_bf16 v[80:95], v[112:115], v[176:179], v[80:95]
    v_add_u32 v48, 0x10000, v48
    v_add_u32 v49, 0x10000, v49
    v_add_u32 v50, 0x10000, v50
    v_add_u32 v51, 0x10000, v51
    ds_read_b64_tr_b16 v[96:97], v48 offset:16384
    ds_read_b64_tr_b16 v[98:99], v48 offset:16896
    s_add_u32 m0, s54, 32768
    s_add_u32 s68, s62, s19
    buffer_load_dwordx4 v43, s[36:39], s68 offen lds
    v_mfma_f32_32x32x16_bf16 v[80:95], v[116:119], v[180:183], v[80:95]
    ds_read_b64_tr_b16 v[100:101], v48 offset:18432
    ds_read_b64_tr_b16 v[102:103], v48 offset:18944
    ds_read_b64_tr_b16 v[104:105], v49 offset:16384
    ds_read_b64_tr_b16 v[106:107], v49 offset:16896
    v_rcp_f32 v30, v30
    v_fma_f32 v31, v31, v19, -1.0
    v_fma_f32 v70, v70, v30, v70
    v_rcp_f32 v31, v31
    s_nop 0
    v_fma_f32 v71, v71, v31, v71
    v_mfma_f32_32x32x16_bf16 v[80:95], v[120:123], v[184:187], v[80:95]
    ds_read_b64_tr_b16 v[108:109], v49 offset:18432
    ds_read_b64_tr_b16 v[110:111], v49 offset:18944
    v_cvt_pk_bf16_f32 v16, v64, v65
    v_cvt_pk_bf16_f32 v17, v66, v67
    v_cvt_pk_bf16_f32 v18, v68, v69
    v_cvt_pk_bf16_f32 v19, v70, v71
    buffer_store_dwordx4 v[16:19], v42, s[32:35], s69 offen offset:0 sc1
    v_mul_f32 v72, v72, v41
    v_mfma_f32_32x32x16_bf16 v[80:95], v[124:127], v[188:191], v[80:95]
    ds_read_b64_tr_b16 v[112:113], v50 offset:16384
    ds_read_b64_tr_b16 v[114:115], v50 offset:16896
    ds_read_b64_tr_b16 v[116:117], v50 offset:18432
    ds_read_b64_tr_b16 v[118:119], v50 offset:18944
    v_exp_f32 v24, v72
    v_mul_f32 v73, v73, v41
    v_fma_f32 v20, v24, -0.5, -1.0
    v_exp_f32 v25, v73
    v_mul_f32 v74, v74, v41
    s_waitcnt lgkmcnt(6)
    v_mfma_f32_32x32x16_bf16 v[80:95], v[96:99], v[192:195], v[80:95]
    ds_read_b64_tr_b16 v[120:121], v51 offset:16384
    ds_read_b64_tr_b16 v[122:123], v51 offset:16896
    v_mfma_f32_16x16x32_bf16 v[60:63], v[56:59], v[96:99], v[60:63]
    s_add_u32 m0, s54, 40960
    s_add_u32 s68, s63, s19
    buffer_load_dwordx4 v43, s[36:39], s68 offen lds
    v_mfma_f32_32x32x16_bf16 v[80:95], v[100:103], v[196:199], v[80:95]
    ds_read_b64_tr_b16 v[124:125], v51 offset:18432
    ds_read_b64_tr_b16 v[126:127], v51 offset:18944
    v_mfma_f32_16x16x32_bf16 v[60:63], v[56:59], v[100:103], v[60:63]
    v_fma_f32 v24, v24, v20, -1.0
    v_fma_f32 v21, v25, -0.5, -1.0
    v_exp_f32 v26, v74
    v_mul_f32 v75, v75, v41
    v_mfma_f32_32x32x16_bf16 v[80:95], v[104:107], v[200:203], v[80:95]
    v_rcp_f32 v24, v24
    v_fma_f32 v25, v25, v21, -1.0
    v_fma_f32 v22, v26, -0.5, -1.0
    v_exp_f32 v27, v75
    v_mul_f32 v76, v76, v41
    v_fma_f32 v72, v72, v24, v72
    v_rcp_f32 v25, v25
    s_waitcnt lgkmcnt(2)
    v_mfma_f32_32x32x16_bf16 v[80:95], v[108:111], v[204:207], v[80:95]
    v_fma_f32 v26, v26, v22, -1.0
    v_fma_f32 v23, v27, -0.5, -1.0
    v_exp_f32 v28, v76
    v_mul_f32 v77, v77, v41
    v_fma_f32 v73, v73, v25, v73
    s_waitcnt vmcnt(13) lgkmcnt(0)
    s_barrier
    v_mfma_f32_32x32x16_bf16 v[80:95], v[112:115], v[208:211], v[80:95]
    ds_read_b64_tr_b16 v[96:97], v48 offset:32768
    ds_read_b64_tr_b16 v[98:99], v48 offset:33280
    v_rcp_f32 v26, v26
    v_fma_f32 v27, v27, v23, -1.0
    v_fma_f32 v20, v28, -0.5, -1.0
    v_exp_f32 v29, v77
    v_mul_f32 v78, v78, v41
    v_mfma_f32_32x32x16_bf16 v[80:95], v[116:119], v[212:215], v[80:95]
    ds_read_b64_tr_b16 v[100:101], v48 offset:34816
    ds_read_b64_tr_b16 v[102:103], v48 offset:35328
    ds_read_b64_tr_b16 v[104:105], v49 offset:32768
    ds_read_b64_tr_b16 v[106:107], v49 offset:33280
    v_fma_f32 v74, v74, v26, v74
    v_rcp_f32 v27, v27
    v_fma_f32 v28, v28, v20, -1.0
    v_fma_f32 v21, v29, -0.5, -1.0
    v_mfma_f32_32x32x16_bf16 v[80:95], v[120:123], v[216:219], v[80:95]
    ds_read_b64_tr_b16 v[108:109], v49 offset:34816
    ds_read_b64_tr_b16 v[110:111], v49 offset:35328
    v_exp_f32 v30, v78
    v_mul_f32 v79, v79, v41
    v_fma_f32 v75, v75, v27, v75
    v_rcp_f32 v28, v28
    v_mfma_f32_32x32x16_bf16 v[80:95], v[124:127], v[220:223], v[80:95]
    ds_read_b64_tr_b16 v[112:113], v50 offset:32768
    ds_read_b64_tr_b16 v[114:115], v50 offset:33280
    ds_read_b64_tr_b16 v[116:117], v50 offset:34816
    ds_read_b64_tr_b16 v[118:119], v50 offset:35328
    v_fma_f32 v29, v29, v21, -1.0
    v_fma_f32 v22, v30, -0.5, -1.0
    v_exp_f32 v31, v79
    v_fma_f32 v76, v76, v28, v76
    s_waitcnt lgkmcnt(6)
    v_mfma_f32_32x32x16_bf16 v[80:95], v[96:99], v[224:227], v[80:95]
    ds_read_b64_tr_b16 v[120:121], v51 offset:32768
    ds_read_b64_tr_b16 v[122:123], v51 offset:33280
    v_mfma_f32_16x16x32_bf16 v[60:63], v[56:59], v[96:99], v[60:63]
    v_rcp_f32 v29, v29
    v_fma_f32 v30, v30, v22, -1.0
    v_fma_f32 v23, v31, -0.5, -1.0
    v_mfma_f32_32x32x16_bf16 v[80:95], v[100:103], v[228:231], v[80:95]
    ds_read_b64_tr_b16 v[124:125], v51 offset:34816
    ds_read_b64_tr_b16 v[126:127], v51 offset:35328
    v_mfma_f32_16x16x32_bf16 v[60:63], v[56:59], v[100:103], v[60:63]
    v_fma_f32 v77, v77, v29, v77
    v_rcp_f32 v30, v30
    v_mfma_f32_32x32x16_bf16 v[80:95], v[104:107], v[232:235], v[80:95]
    v_fma_f32 v31, v31, v23, -1.0
    v_fma_f32 v78, v78, v30, v78
    v_rcp_f32 v31, v31
    s_nop 0
    v_fma_f32 v79, v79, v31, v79
    v_cvt_pk_bf16_f32 v20, v72, v73
    v_cvt_pk_bf16_f32 v21, v74, v75
    v_cvt_pk_bf16_f32 v22, v76, v77
    s_waitcnt lgkmcnt(2)
    v_mfma_f32_32x32x16_bf16 v[80:95], v[108:111], v[236:239], v[80:95]
    ds_write_b32 v40, v60
    v_cvt_pk_bf16_f32 v23, v78, v79
    buffer_store_dwordx4 v[20:23], v42, s[32:35], s69 offen offset:1024 sc1
    s_waitcnt vmcnt(0) lgkmcnt(0)
    s_barrier
    v_mfma_f32_32x32x16_bf16 v[80:95], v[112:115], v[240:243], v[80:95]
    s_cmp_lg_u32 s48, 0
    s_cbranch_scc1 L_w021
    v_mov_b32 v61, s3
    buffer_store_dword v61, off, s[32:35], s16 offset:0 sc1
L_w021:
    s_sub_u32 s10, s48, 0
    s_and_b32 s10, s10, 7
    s_mov_b32 m0, 153344
    s_bfe_u32 s11, s2, 0x50003
    s_mul_i32 s11, s11, 7
    s_add_u32 s11, s10, s11
    s_add_u32 s11, s11, 0
    s_lshl_b32 s11, s11, 13
    s_cmp_ge_u32 s10, 7
    s_cselect_b32 s11, 0x80000000, s11
    v_lshl_add_u32 v61, v33, 3, s11
    buffer_load_dword v61, s[40:43], 0 offen lds
    ds_read2_b32 v[8:9], v39 offset0:0 offset1:32
    ds_read2_b32 v[10:11], v39 offset0:64 offset1:96
    ds_read_b64_tr_b16 v[96:97], v48 offset:49152
    ds_read_b64_tr_b16 v[98:99], v48 offset:49664
    v_mfma_f32_32x32x16_bf16 v[80:95], v[116:119], v[244:247], v[80:95]
    ds_read_b64_tr_b16 v[100:101], v48 offset:51200
    ds_read_b64_tr_b16 v[102:103], v48 offset:51712
    ds_read_b64_tr_b16 v[104:105], v49 offset:49152
    ds_read_b64_tr_b16 v[106:107], v49 offset:49664
    v_lshlrev_b32 v12, 16, v36
    v_mov_b32 v2, v36
    v_mov_b32 v3, 0
    s_waitcnt lgkmcnt(7)
    v_add_f32 v8, v8, v9
    v_mfma_f32_32x32x16_bf16 v[80:95], v[120:123], v[248:251], v[80:95]
    ds_read_b64_tr_b16 v[108:109], v49 offset:51200
    ds_read_b64_tr_b16 v[110:111], v49 offset:51712
    s_waitcnt lgkmcnt(8)
    v_add_f32 v10, v10, v11
    v_add_f32 v8, v8, v10
    v_cvt_pk_bf16_f32 v9, v8, v8
    v_mfma_f32_32x32x16_bf16 v[80:95], v[124:127], v[252:255], v[80:95]
    ds_read_b64_tr_b16 v[112:113], v50 offset:49152
    ds_read_b64_tr_b16 v[114:115], v50 offset:49664
    ds_read_b64_tr_b16 v[116:117], v50 offset:51200
    ds_read_b64_tr_b16 v[118:119], v50 offset:51712
    v_cvt_pk_bf16_f32 v1, v8, v12
    v_and_b32 v9, 0xffff0000, v9
    v_sub_f32 v9, v8, v9
    v_cvt_pk_bf16_f32 v0, v8, v9
    s_nop 1
    v_mfma_f32_32x32x16_bf16 v[80:95], v[0:3], v[52:55], v[80:95]
    s_waitcnt lgkmcnt(6)
    v_mfma_f32_32x32x16_bf16 v[64:79], v[96:99], v[128:131], 0
    ds_read_b64_tr_b16 v[120:121], v51 offset:49152
    ds_read_b64_tr_b16 v[122:123], v51 offset:49664
    v_mfma_f32_16x16x32_bf16 v[60:63], v[56:59], v[96:99], 0
    v_mfma_f32_32x32x16_bf16 v[64:79], v[100:103], v[132:135], v[64:79]
    ds_read_b64_tr_b16 v[124:125], v51 offset:51200
    ds_read_b64_tr_b16 v[126:127], v51 offset:51712
    v_mfma_f32_16x16x32_bf16 v[60:63], v[56:59], v[100:103], v[60:63]
    s_lshl_b32 s69, s65, 5
    s_add_u32 s69, s69, s55
    s_nop 0
    v_mul_f32 v80, v80, v41
    v_mfma_f32_32x32x16_bf16 v[64:79], v[104:107], v[136:139], v[64:79]
    v_exp_f32 v24, v80
    v_mul_f32 v81, v81, v41
    v_fma_f32 v16, v24, -0.5, -1.0
    v_exp_f32 v25, v81
    v_mul_f32 v82, v82, v41
    v_fma_f32 v24, v24, v16, -1.0
    v_fma_f32 v17, v25, -0.5, -1.0
    s_waitcnt lgkmcnt(4)
    v_mfma_f32_32x32x16_bf16 v[64:79], v[108:111], v[140:143], v[64:79]
    v_exp_f32 v26, v82
    v_mul_f32 v83, v83, v41
    v_rcp_f32 v24, v24
    s_waitcnt lgkmcnt(0)
    s_barrier
    v_mfma_f32_32x32x16_bf16 v[64:79], v[112:115], v[144:147], v[64:79]
    s_sub_u32 s10, s48, 7
    s_and_b32 s10, s10, 7
    s_mov_b32 m0, 153344
    s_bfe_u32 s11, s2, 0x50003
    s_mul_i32 s11, s11, 2
    s_add_u32 s11, s10, s11
    s_add_u32 s11, s11, 0
    s_lshl_b32 s11, s11, 13
    s_cmp_ge_u32 s10, 2
    s_cselect_b32 s11, 0x80000000, s11
    v_lshl_add_u32 v61, v33, 3, s11
    buffer_load_dword v61, s[44:47], 0 offen lds
    v_add_u32 v48, 0xffff0000, v48
    v_add_u32 v49, 0xffff0000, v49
    v_add_u32 v50, 0xffff0000, v50
    v_add_u32 v51, 0xffff0000, v51
    ds_read_b64_tr_b16 v[96:97], v48 offset:0
    ds_read_b64_tr_b16 v[98:99], v48 offset:512
    v_and_b32 v32, 0x380, v33
    buffer_load_dword v32, v32, s[32:35], s81 offen offset:1024 sc1
    v_mfma_f32_32x32x16_bf16 v[64:79], v[116:119], v[148:151], v[64:79]
    ds_read_b64_tr_b16 v[100:101], v48 offset:2048
    ds_read_b64_tr_b16 v[102:103], v48 offset:2560
    ds_read_b64_tr_b16 v[104:105], v49 offset:0
    ds_read_b64_tr_b16 v[106:107], v49 offset:512
    v_fma_f32 v25, v25, v17, -1.0
    v_fma_f32 v18, v26, -0.5, -1.0
    v_exp_f32 v27, v83
    v_mul_f32 v84, v84, v41
    v_fma_f32 v80, v80, v24, v80
    v_mfma_f32_32x32x16_bf16 v[64:79], v[120:123], v[152:155], v[64:79]
    ds_read_b64_tr_b16 v[108:109], v49 offset:2048
    ds_read_b64_tr_b16 v[110:111], v49 offset:2560
    v_rcp_f32 v25, v25
    v_fma_f32 v26, v26, v18, -1.0
    v_fma_f32 v19, v27, -0.5, -1.0
    v_exp_f32 v28, v84
    v_mul_f32 v85, v85, v41
    v_mfma_f32_32x32x16_bf16 v[64:79], v[124:127], v[156:159], v[64:79]
    ds_read_b64_tr_b16 v[112:113], v50 offset:0
    ds_read_b64_tr_b16 v[114:115], v50 offset:512
    ds_read_b64_tr_b16 v[116:117], v50 offset:2048
    ds_read_b64_tr_b16 v[118:119], v50 offset:2560
    v_fma_f32 v81, v81, v25, v81
    v_rcp_f32 v26, v26
    v_fma_f32 v27, v27, v19, -1.0
    v_fma_f32 v16, v28, -0.5, -1.0
    v_exp_f32 v29, v85
    s_waitcnt lgkmcnt(6)
    v_mfma_f32_32x32x16_bf16 v[64:79], v[96:99], v[160:163], v[64:79]
    ds_read_b64_tr_b16 v[120:121], v51 offset:0
    ds_read_b64_tr_b16 v[122:123], v51 offset:512
    v_mfma_f32_16x16x32_bf16 v[60:63], v[56:59], v[96:99], v[60:63]
    v_mul_f32 v86, v86, v41
    v_fma_f32 v82, v82, v26, v82
    v_rcp_f32 v27, v27
    v_mfma_f32_32x32x16_bf16 v[64:79], v[100:103], v[164:167], v[64:79]
    ds_read_b64_tr_b16 v[124:125], v51 offset:2048
    ds_read_b64_tr_b16 v[126:127], v51 offset:2560
    v_mfma_f32_16x16x32_bf16 v[60:63], v[56:59], v[100:103], v[60:63]
    v_fma_f32 v28, v28, v16, -1.0
    v_fma_f32 v17, v29, -0.5, -1.0
    v_exp_f32 v30, v86
    v_mfma_f32_32x32x16_bf16 v[64:79], v[104:107], v[168:171], v[64:79]
    v_mul_f32 v87, v87, v41
    v_fma_f32 v83, v83, v27, v83
    v_rcp_f32 v28, v28
    v_fma_f32 v29, v29, v17, -1.0
    v_fma_f32 v18, v30, -0.5, -1.0
    v_exp_f32 v31, v87
    s_waitcnt lgkmcnt(3)
    v_mfma_f32_32x32x16_bf16 v[64:79], v[108:111], v[172:175], v[64:79]
    v_fma_f32 v84, v84, v28, v84
    v_rcp_f32 v29, v29
    v_fma_f32 v30, v30, v18, -1.0
    v_fma_f32 v19, v31, -0.5, -1.0
    v_fma_f32 v85, v85, v29, v85
    s_waitcnt lgkmcnt(0)
    s_barrier
    v_mfma_f32_32x32x16_bf16 v[64:79], v[112:115], v[176:179], v[64:79]
    ds_read_b64_tr_b16 v[96:97], v48 offset:16384
    ds_read_b64_tr_b16 v[98:99], v48 offset:16896
    s_add_u32 m0, s53, 81920
    s_add_u32 s68, s73, 0
    buffer_load_dwordx4 v44, s[40:43], s68 offen lds
    v_rcp_f32 v30, v30
    v_fma_f32 v31, v31, v19, -1.0
    v_fma_f32 v86, v86, v30, v86
    v_mfma_f32_32x32x16_bf16 v[64:79], v[116:119], v[180:183], v[64:79]
    ds_read_b64_tr_b16 v[100:101], v48 offset:18432
    ds_read_b64_tr_b16 v[102:103], v48 offset:18944
    ds_read_b64_tr_b16 v[104:105], v49 offset:16384
    ds_read_b64_tr_b16 v[106:107], v49 offset:16896
    v_rcp_f32 v31, v31
    s_nop 0
    v_fma_f32 v87, v87, v31, v87
    v_cvt_pk_bf16_f32 v16, v80, v81
    v_cvt_pk_bf16_f32 v17, v82, v83
    v_cvt_pk_bf16_f32 v18, v84, v85
    v_cvt_pk_bf16_f32 v19, v86, v87
    v_mfma_f32_32x32x16_bf16 v[64:79], v[120:123], v[184:187], v[64:79]
    ds_read_b64_tr_b16 v[108:109], v49 offset:18432
    ds_read_b64_tr_b16 v[110:111], v49 offset:18944
    buffer_load_dwordx4 v45, s[40:43], s68 offen offset:1024 lds
    buffer_store_dwordx4 v[16:19], v42, s[32:35], s69 offen offset:0 sc1
    v_mul_f32 v88, v88, v41
    v_exp_f32 v24, v88
    v_mfma_f32_32x32x16_bf16 v[64:79], v[124:127], v[188:191], v[64:79]
    ds_read_b64_tr_b16 v[112:113], v50 offset:16384
    ds_read_b64_tr_b16 v[114:115], v50 offset:16896
    ds_read_b64_tr_b16 v[116:117], v50 offset:18432
    ds_read_b64_tr_b16 v[118:119], v50 offset:18944
    v_mul_f32 v89, v89, v41
    v_fma_f32 v20, v24, -0.5, -1.0
    v_exp_f32 v25, v89
    v_mul_f32 v90, v90, v41
    v_fma_f32 v24, v24, v20, -1.0
    v_fma_f32 v21, v25, -0.5, -1.0
    s_waitcnt lgkmcnt(6)
    v_mfma_f32_32x32x16_bf16 v[64:79], v[96:99], v[192:195], v[64:79]
    ds_read_b64_tr_b16 v[120:121], v51 offset:16384
    ds_read_b64_tr_b16 v[122:123], v51 offset:16896
    v_mfma_f32_16x16x32_bf16 v[60:63], v[56:59], v[96:99], v[60:63]
    s_add_u32 m0, s53, 0
    s_add_u32 s68, s73, 458752
    buffer_load_dwordx4 v44, s[40:43], s68 offen lds
    v_mfma_f32_32x32x16_bf16 v[64:79], v[100:103], v[196:199], v[64:79]
    ds_read_b64_tr_b16 v[124:125], v51 offset:18432
    ds_read_b64_tr_b16 v[126:127], v51 offset:18944
    v_mfma_f32_16x16x32_bf16 v[60:63], v[56:59], v[100:103], v[60:63]
    v_exp_f32 v26, v90
    v_mul_f32 v91, v91, v41
    v_rcp_f32 v24, v24
    v_mfma_f32_32x32x16_bf16 v[64:79], v[104:107], v[200:203], v[64:79]
    buffer_load_dwordx4 v45, s[40:43], s68 offen offset:1024 lds
    v_fma_f32 v25, v25, v21, -1.0
    v_fma_f32 v22, v26, -0.5, -1.0
    v_exp_f32 v27, v91
    v_mul_f32 v92, v92, v41
    v_fma_f32 v88, v88, v24, v88
    v_rcp_f32 v25, v25
    s_waitcnt lgkmcnt(2)
    v_mfma_f32_32x32x16_bf16 v[64:79], v[108:111], v[204:207], v[64:79]
    v_fma_f32 v26, v26, v22, -1.0
    v_fma_f32 v23, v27, -0.5, -1.0
    v_exp_f32 v28, v92
    v_mul_f32 v93, v93, v41
    v_fma_f32 v89, v89, v25, v89
    s_cmp_lg_u32 s48, 0
    s_cbranch_scc1 L_po33
    s_mov_b32 s11, 0
    s_waitcnt vmcnt(5)
L_pc32:
    v_cmp_eq_u32 vcc, s3, v32
    s_nop 2
    s_cmp_eq_u64 vcc, -1
    s_cbranch_scc1 L_po33
    s_add_u32 s11, s11, 1
    s_cmp_ge_u32 s11, 0x40000
    s_cbranch_scc1 L_po33
    s_sleep 1
    v_and_b32 v32, 0x380, v33
    buffer_load_dword v32, v32, s[32:35], s81 offen offset:1024 sc1
    s_waitcnt vmcnt(0)
    s_branch L_pc32
L_po33:
    s_waitcnt lgkmcnt(0)
    s_barrier
    v_mfma_f32_32x32x16_bf16 v[64:79], v[112:115], v[208:211], v[64:79]
    ds_read_b64_tr_b16 v[96:97], v48 offset:49152
    ds_read_b64_tr_b16 v[98:99], v48 offset:49664
    s_add_u32 s68, s70, 0
    buffer_load_dwordx4 v[144:147], v33, s[32:35], s68 offen sc1
    v_rcp_f32 v26, v26
    v_fma_f32 v27, v27, v23, -1.0
    v_fma_f32 v20, v28, -0.5, -1.0
    v_mfma_f32_32x32x16_bf16 v[64:79], v[116:119], v[212:215], v[64:79]
    ds_read_b64_tr_b16 v[100:101], v48 offset:51200
    ds_read_b64_tr_b16 v[102:103], v48 offset:51712
    ds_read_b64_tr_b16 v[104:105], v49 offset:49152
    ds_read_b64_tr_b16 v[106:107], v49 offset:49664
    v_exp_f32 v29, v93
    v_mul_f32 v94, v94, v41
    v_fma_f32 v90, v90, v26, v90
    v_rcp_f32 v27, v27
    v_fma_f32 v28, v28, v20, -1.0
    v_fma_f32 v21, v29, -0.5, -1.0
    v_mfma_f32_32x32x16_bf16 v[64:79], v[120:123], v[216:219], v[64:79]
    ds_read_b64_tr_b16 v[108:109], v49 offset:51200
    ds_read_b64_tr_b16 v[110:111], v49 offset:51712
    buffer_load_dwordx4 v[148:151], v33, s[32:35], s68 offen offset:1024 sc1
    v_exp_f32 v30, v94
    v_mul_f32 v95, v95, v41
    v_fma_f32 v91, v91, v27, v91
    v_mfma_f32_32x32x16_bf16 v[64:79], v[124:127], v[220:223], v[64:79]
    ds_read_b64_tr_b16 v[112:113], v50 offset:49152
    ds_read_b64_tr_b16 v[114:115], v50 offset:49664
    ds_read_b64_tr_b16 v[116:117], v50 offset:51200
    ds_read_b64_tr_b16 v[118:119], v50 offset:51712
    v_rcp_f32 v28, v28
    v_fma_f32 v29, v29, v21, -1.0
    v_fma_f32 v22, v30, -0.5, -1.0
    v_exp_f32 v31, v95
    v_fma_f32 v92, v92, v28, v92
    s_waitcnt lgkmcnt(6)
    v_mfma_f32_32x32x16_bf16 v[64:79], v[96:99], v[224:227], v[64:79]
    ds_read_b64_tr_b16 v[120:121], v51 offset:49152
    ds_read_b64_tr_b16 v[122:123], v51 offset:49664
    v_mfma_f32_16x16x32_bf16 v[60:63], v[56:59], v[96:99], v[60:63]
    s_add_u32 s68, s70, 28672
    buffer_load_dwordx4 v[152:155], v33, s[32:35], s68 offen sc1
    v_rcp_f32 v29, v29
    v_mfma_f32_32x32x16_bf16 v[64:79], v[100:103], v[228:231], v[64:79]
    ds_read_b64_tr_b16 v[124:125], v51 offset:51200
    ds_read_b64_tr_b16 v[126:127], v51 offset:51712
    v_mfma_f32_16x16x32_bf16 v[60:63], v[56:59], v[100:103], v[60:63]
    v_fma_f32 v30, v30, v22, -1.0
    v_fma_f32 v23, v31, -0.5, -1.0
    v_fma_f32 v93, v93, v29, v93
    v_rcp_f32 v30, v30
    v_mfma_f32_32x32x16_bf16 v[64:79], v[104:107], v[232:235], v[64:79]
    buffer_load_dwordx4 v[156:159], v33, s[32:35], s68 offen offset:1024 sc1
    v_fma_f32 v31, v31, v23, -1.0
    v_fma_f32 v94, v94, v30, v94
    v_rcp_f32 v31, v31
    s_nop 0
    v_fma_f32 v95, v95, v31, v95
    v_cvt_pk_bf16_f32 v20, v88, v89
    s_waitcnt lgkmcnt(2)
    v_mfma_f32_32x32x16_bf16 v[64:79], v[108:111], v[236:239], v[64:79]
    ds_write_b32 v40, v60
    v_cvt_pk_bf16_f32 v21, v90, v91
    v_cvt_pk_bf16_f32 v22, v92, v93
    v_cvt_pk_bf16_f32 v23, v94, v95
    buffer_store_dwordx4 v[20:23], v42, s[32:35], s69 offen offset:1024 sc1
    s_waitcnt lgkmcnt(0)
    s_barrier
    v_mfma_f32_32x32x16_bf16 v[64:79], v[112:115], v[240:243], v[64:79]
    ds_read2_b32 v[8:9], v39 offset0:0 offset1:32
    ds_read2_b32 v[10:11], v39 offset0:64 offset1:96
    v_and_b32 v49, 0x38, v48
    v_bfe_u32 v48, v48, 7, 7
    v_lshl_add_u32 v48, v48, 6, v49
    s_lshl_b32 s12, s50, 5
    v_xor_b32 v48, s12, v48
    v_xor_b32 v49, 0x800, v48
    v_add_u32 v48, 0x10000, v48
    v_add_u32 v49, 0x10000, v49
    ds_read_b64_tr_b16 v[96:97], v48 offset:0
    ds_read_b64_tr_b16 v[98:99], v48 offset:256
    s_add_u32 s68, s70, 57344
    buffer_load_dwordx4 v[176:179], v33, s[32:35], s68 offen sc1
    v_mfma_f32_32x32x16_bf16 v[64:79], v[116:119], v[244:247], v[64:79]
    ds_read_b64_tr_b16 v[100:101], v48 offset:1024
    ds_read_b64_tr_b16 v[102:103], v48 offset:1280
    ds_read_b64_tr_b16 v[104:105], v49 offset:0
    ds_read_b64_tr_b16 v[106:107], v49 offset:256
    v_mov_b32 v2, 0
    v_mov_b32 v3, 0
    s_waitcnt lgkmcnt(6)
    v_add_f32 v8, v8, v9
    v_mfma_f32_32x32x16_bf16 v[64:79], v[120:123], v[248:251], v[64:79]
    ds_read_b64_tr_b16 v[108:109], v49 offset:1024
    ds_read_b64_tr_b16 v[110:111], v49 offset:1280
    v_add_f32 v10, v10, v11
    v_add_f32 v8, v8, v10
    v_cvt_pk_bf16_f32 v9, v8, v8
    v_cvt_pk_bf16_f32 v1, v8, 0
    buffer_load_dwordx4 v[180:183], v33, s[32:35], s68 offen offset:1024 sc1
    v_mfma_f32_32x32x16_bf16 v[64:79], v[124:127], v[252:255], v[64:79]
    ds_read_b64_tr_b16 v[112:113], v48 offset:8192
    ds_read_b64_tr_b16 v[114:115], v48 offset:8448
    ds_read_b64_tr_b16 v[116:117], v48 offset:9216
    ds_read_b64_tr_b16 v[118:119], v48 offset:9472
    v_and_b32 v9, 0xffff0000, v9
    v_sub_f32 v9, v8, v9
    v_cvt_pk_bf16_f32 v0, v8, v9
    s_nop 1
    v_mfma_f32_32x32x16_bf16 v[64:79], v[0:3], v[52:55], v[64:79]
    s_add_u32 m0, s53, 16384
    s_add_u32 s68, s73, 917504
    buffer_load_dwordx4 v44, s[40:43], s68 offen lds
    s_waitcnt lgkmcnt(5)
    v_mfma_f32_32x32x16_bf16 v[80:95], v[96:99], v[128:131], 0
    ds_read_b64_tr_b16 v[120:121], v49 offset:8192
    ds_read_b64_tr_b16 v[122:123], v49 offset:8448
    v_mfma_f32_16x16x32_bf16 v[60:63], v[56:59], v[96:99], 0
    v_mfma_f32_32x32x16_bf16 v[80:95], v[100:103], v[132:135], v[80:95]
    ds_read_b64_tr_b16 v[124:125], v49 offset:9216
    ds_read_b64_tr_b16 v[126:127], v49 offset:9472
    v_mfma_f32_16x16x32_bf16 v[60:63], v[56:59], v[100:103], v[60:63]
    buffer_load_dwordx4 v45, s[40:43], s68 offen offset:1024 lds
    ds_read_b64_tr_b16 v[4:5], v37
    ds_read_b64_tr_b16 v[6:7], v37 offset:256
    v_bfe_u32 v8, v33, 8, 1
    v_add_u32 v8, -1, v8
    v_mfma_f32_32x32x16_bf16 v[80:95], v[104:107], v[136:139], v[80:95]
    s_waitcnt lgkmcnt(6)
    v_mfma_f32_16x16x32_bf16 v[60:63], v[56:59], v[112:115], v[60:63]
    v_cvt_pk_bf16_f32 v20, v72, v73
    v_cvt_pk_bf16_f32 v21, v74, v75
    v_cvt_pk_bf16_f32 v22, v76, v77
    v_cvt_pk_bf16_f32 v23, v78, v79
    v_cvt_pk_bf16_f32 v16, v64, v65
    v_cvt_pk_bf16_f32 v17, v66, v67
    v_cvt_pk_bf16_f32 v18, v68, v69
    v_cvt_pk_bf16_f32 v19, v70, v71
    v_mfma_f32_32x32x16_bf16 v[80:95], v[108:111], v[140:143], v[80:95]
    v_mfma_f32_16x16x32_bf16 v[60:63], v[56:59], v[116:119], v[60:63]
    s_waitcnt lgkmcnt(1)
    v_and_b32 v0, v4, v8
    v_and_b32 v1, v5, v8
    s_waitcnt lgkmcnt(0)
    v_and_b32 v2, v6, v8
    v_and_b32 v3, v7, v8
    s_waitcnt vmcnt(4)
    s_barrier
    v_mfma_f32_32x32x16_bf16 v[80:95], v[112:115], v[160:163], v[80:95]
    s_cmp_lg_u32 s48, 0
    s_cbranch_scc1 L_w022
    v_mov_b32 v61, s3
    buffer_store_dword v61, off, s[32:35], s16 offset:4 sc1
L_w022:
    v_add_u32 v48, 0xffff0000, v48
    v_add_u32 v49, 0xffff0000, v49
    ds_read_b64_tr_b16 v[96:97], v48 offset:32768
    ds_read_b64_tr_b16 v[98:99], v48 offset:33024
    s_add_u32 s68, s70, 86016
    buffer_load_dwordx4 v[184:187], v33, s[32:35], s68 offen sc1
    v_mfma_f32_32x32x16_bf16 v[80:95], v[116:119], v[164:167], v[80:95]
    ds_read_b64_tr_b16 v[100:101], v48 offset:33792
    ds_read_b64_tr_b16 v[102:103], v48 offset:34048
    ds_read_b64_tr_b16 v[104:105], v49 offset:32768
    ds_read_b64_tr_b16 v[106:107], v49 offset:33024
    v_xor_b32 v4, v4, v0
    v_xor_b32 v5, v5, v1
    v_xor_b32 v6, v6, v2
    v_xor_b32 v7, v7, v3
    s_nop 1
    v_mfma_f32_32x32x16_bf16 v[64:79], v[4:7], v[20:23], 0
    v_mfma_f32_32x32x16_bf16 v[80:95], v[120:123], v[168:171], v[80:95]
    ds_read_b64_tr_b16 v[108:109], v49 offset:33792
    ds_read_b64_tr_b16 v[110:111], v49 offset:34048
    buffer_load_dwordx4 v[188:191], v33, s[32:35], s68 offen offset:1024 sc1
    v_mfma_f32_32x32x16_bf16 v[64:79], v[0:3], v[16:19], v[64:79]
    v_mfma_f32_32x32x16_bf16 v[80:95], v[124:127], v[172:175], v[80:95]
    ds_read_b64_tr_b16 v[112:113], v48 offset:40960
    ds_read_b64_tr_b16 v[114:115], v48 offset:41216
    ds_read_b64_tr_b16 v[116:117], v48 offset:41984
    ds_read_b64_tr_b16 v[118:119], v48 offset:42240
    s_waitcnt lgkmcnt(9)
    v_mfma_f32_32x32x16_bf16 v[80:95], v[96:99], v[192:195], v[80:95]
    ds_read_b64_tr_b16 v[120:121], v49 offset:40960
    ds_read_b64_tr_b16 v[122:123], v49 offset:41216
    v_mfma_f32_16x16x32_bf16 v[60:63], v[56:59], v[96:99], v[60:63]
    s_add_u32 m0, s53, 49152
    s_add_u32 s68, s73, 1376256
    buffer_load_dwordx4 v44, s[40:43], s68 offen lds
    s_waitcnt lgkmcnt(8)
    v_mfma_f32_32x32x16_bf16 v[80:95], v[100:103], v[196:199], v[80:95]
    ds_read_b64_tr_b16 v[124:125], v49 offset:41984
    ds_read_b64_tr_b16 v[126:127], v49 offset:42240
    v_mfma_f32_16x16x32_bf16 v[60:63], v[56:59], v[100:103], v[60:63]
    v_max3_f32 v8, v64, v65, v66
    v_max3_f32 v9, -v64, -v65, -v66
    v_max3_f32 v8, v8, v67, v68
    v_max3_f32 v9, v9, -v67, -v68
    v_max3_f32 v8, v8, v69, v70
    v_mfma_f32_32x32x16_bf16 v[80:95], v[104:107], v[200:203], v[80:95]
    s_waitcnt lgkmcnt(4)
    v_mfma_f32_16x16x32_bf16 v[60:63], v[56:59], v[112:115], v[60:63]
    buffer_load_dwordx4 v45, s[40:43], s68 offen offset:1024 lds
    v_max3_f32 v9, v9, -v69, -v70
    v_max_f32 v8, v8, v71
    v_max_f32_e64 v9, v9, -v71
    v_max3_f32 v10, v72, v73, v74
    v_max3_f32 v11, -v72, -v73, -v74
    v_mfma_f32_32x32x16_bf16 v[80:95], v[108:111], v[204:207], v[80:95]
    v_mfma_f32_16x16x32_bf16 v[60:63], v[56:59], v[116:119], v[60:63]
    v_max3_f32 v10, v10, v75, v76
    v_max3_f32 v11, v11, -v75, -v76
    v_max3_f32 v10, v10, v77, v78
    v_max3_f32 v11, v11, -v77, -v78
    v_max_f32 v10, v10, v79
    s_nop 2
    ds_write_b32 v40, v60
    s_waitcnt lgkmcnt(0)
    s_barrier
    s_add_u32 m0, s53, 65536
    s_add_u32 s68, s73, 65536
    buffer_load_dwordx4 v44, s[40:43], s68 offen lds
    v_mfma_f32_32x32x16_bf16 v[80:95], v[112:115], v[224:227], v[80:95]
    ds_read2_b32 v[168:169], v39 offset0:0 offset1:32
    ds_read2_b32 v[170:171], v39 offset0:64 offset1:96
    v_lshrrev_b32 v49, 9, v33
    v_bfe_u32 v50, v33, 6, 2
    v_lshl_add_u32 v49, v49, 2, v50
    v_bfe_u32 v48, v33, 8, 1
    v_lshlrev_b32 v48, 5, v48
    v_bfe_u32 v51, v33, 4, 2
    buffer_load_dwordx4 v45, s[40:43], s68 offen offset:1024 lds
    v_max_f32_e64 v11, v11, -v79
    v_permlane32_swap_b32 v8, v9
    s_nop 0
    v_permlane32_swap_b32 v10, v11
    v_max_f32 v8, v8, v9
    v_mfma_f32_32x32x16_bf16 v[80:95], v[116:119], v[228:231], v[80:95]
    v_lshl_add_u32 v48, v51, 3, v48
    v_lshrrev_b32 v50, 1, v50
    v_lshl_add_u32 v48, v50, 6, v48
    v_lshl_add_u32 v48, v49, 7, v48
    v_lshl_add_u32 v48, s49, 12, v48
    v_xor_b32 v49, 64, v48
    v_max_f32 v10, v10, v11
    v_mov_b32 v9, v8
    v_mov_b32 v11, v10
    s_nop 0
    v_permlane32_swap_b32 v8, v9
    v_permlane32_swap_b32 v10, v11
    v_mul_f32_e64 v8, -v8, v41
    v_mul_f32_e64 v9, -v9, v41
    v_mul_f32_e64 v10, -v10, v41
    v_mul_f32_e64 v11, -v11, v41
    v_mfma_f32_32x32x16_bf16 v[80:95], v[120:123], v[232:235], v[80:95]
    v_add_u32 v48, 0x10000, v48
    v_add_u32 v49, 0x10000, v49
    ds_read_b64_tr_b16 v[96:97], v48 offset:16384
    ds_read_b64_tr_b16 v[98:99], v48 offset:17408
    ds_read_b64_tr_b16 v[100:101], v49 offset:16384
    ds_read_b64_tr_b16 v[102:103], v49 offset:17408
    ds_read_b64_tr_b16 v[104:105], v48 offset:18432
    ds_read_b64_tr_b16 v[106:107], v48 offset:19456
    ds_read_b64_tr_b16 v[108:109], v49 offset:18432
    ds_read_b64_tr_b16 v[110:111], v49 offset:19456
    s_add_u32 m0, s53, 131072
    s_add_u32 s68, s73, 524288
    buffer_load_dwordx4 v44, s[40:43], s68 offen lds
    v_fma_f32 v24, v64, v41, v8
    v_fma_f32 v25, v65, v41, v8
    v_fma_f32 v26, v66, v41, v8
    v_fma_f32 v27, v67, v41, v8
    v_fma_f32 v28, v68, v41, v8
    v_mfma_f32_32x32x16_bf16 v[80:95], v[124:127], v[236:239], v[80:95]
    v_lshlrev_b32 v172, 16, v38
    v_mov_b32 v162, v38
    v_mov_b32 v163, 0
    s_waitcnt lgkmcnt(7)
    v_add_f32 v168, v168, v169
    v_add_f32 v170, v170, v171
    v_add_f32 v168, v168, v170
    v_cvt_pk_bf16_f32 v169, v168, v168
    v_cvt_pk_bf16_f32 v161, v168, v172
    v_and_b32 v169, 0xffff0000, v169
    v_sub_f32 v169, v168, v169
    v_cvt_pk_bf16_f32 v160, v168, v169
    s_sub_u32 s12, s50, 1
    v_and_b32 v160, s12, v160
    v_and_b32 v161, s12, v161
    v_and_b32 v162, s12, v162
    buffer_load_dwordx4 v45, s[40:43], s68 offen offset:1024 lds
    s_nop 0
    v_mfma_f32_32x32x16_bf16 v[80:95], v[160:163], v[52:55], v[80:95]
    v_fma_f32 v29, v69, v41, v8
    v_fma_f32 v30, v70, v41, v8
    v_fma_f32 v31, v71, v41, v8
    v_fma_f32 v64, -v64, v41, v9
    v_fma_f32 v65, -v65, v41, v9
    v_fma_f32 v66, -v66, v41, v9
    v_fma_f32 v67, -v67, v41, v9
    v_fma_f32 v68, -v68, v41, v9
    v_fma_f32 v69, -v69, v41, v9
    v_fma_f32 v70, -v70, v41, v9
    v_fma_f32 v71, -v71, v41, v9
    v_exp_f32 v24, v24
    s_waitcnt lgkmcnt(0)
    s_barrier
    s_add_u32 s12, s53, 147456
    v_add_u32 v43, s12, v33
    ds_write_b128 v43, v[88:91]
    ds_write_b128 v43, v[92:95] offset:1024
    v_and_b32 v36, 0xf0, v33
    v_lshlrev_b32 v36, 7, v36
    buffer_load_dword v36, v36, s[32:35], s17 offen offset:0 sc1
    v_add_u32 v48, 0xffff0000, v48
    v_add_u32 v49, 0xffff0000, v49
    ds_read_b64_tr_b16 v[112:113], v48 offset:0
    ds_read_b64_tr_b16 v[114:115], v48 offset:1024
    ds_read_b64_tr_b16 v[116:117], v49 offset:0
    ds_read_b64_tr_b16 v[118:119], v49 offset:1024
    ds_read_b64_tr_b16 v[120:121], v48 offset:2048
    ds_read_b64_tr_b16 v[122:123], v48 offset:3072
    ds_read_b64_tr_b16 v[124:125], v49 offset:2048
    ds_read_b64_tr_b16 v[126:127], v49 offset:3072
    v_and_b32 v32, 0x380, v33
    buffer_load_dword v32, v32, s[32:35], s81 offen offset:1028 sc1
    v_mfma_f32_32x32x16_bf16 v[224:239], v[96:99], v[144:147], 0
    s_add_u32 m0, s53, 98304
    s_add_u32 s68, s73, 983040
    buffer_load_dwordx4 v44, s[40:43], s68 offen lds
    v_exp_f32 v25, v25
    v_exp_f32 v26, v26
    v_exp_f32 v27, v27
    v_exp_f32 v28, v28
    v_exp_f32 v29, v29
    v_exp_f32 v30, v30
    v_exp_f32 v31, v31
    v_exp_f32 v64, v64
    v_exp_f32 v65, v65
    v_mfma_f32_32x32x16_bf16 v[192:207], v[100:103], v[144:147], 0
    buffer_load_dwordx4 v45, s[40:43], s68 offen offset:1024 lds
    v_exp_f32 v66, v66
    v_exp_f32 v67, v67
    v_exp_f32 v68, v68
    v_exp_f32 v69, v69
    v_exp_f32 v70, v70
    v_exp_f32 v71, v71
    v_cvt_pk_bf16_f32 v16, v24, v25
    v_cvt_pk_bf16_f32 v17, v26, v27
    v_cvt_pk_bf16_f32 v18, v28, v29
    v_cvt_pk_bf16_f32 v19, v30, v31
    v_cvt_pk_bf16_f32 v20, v64, v65
    v_cvt_pk_bf16_f32 v21, v66, v67
    v_cvt_pk_bf16_f32 v22, v68, v69
    v_cvt_pk_bf16_f32 v23, v70, v71
    v_mfma_f32_32x32x16_bf16 v[224:239], v[104:107], v[148:151], v[224:239]
    s_add_u32 m0, s53, 114688
    s_add_u32 s68, s73, 1441792
    buffer_load_dwordx4 v44, s[40:43], s68 offen lds
    v_fma_f32 v24, v72, v41, v10
    v_fma_f32 v25, v73, v41, v10
    v_fma_f32 v26, v74, v41, v10
    v_fma_f32 v27, v75, v41, v10
    v_fma_f32 v28, v76, v41, v10
    v_fma_f32 v29, v77, v41, v10
    v_fma_f32 v30, v78, v41, v10
    v_fma_f32 v31, v79, v41, v10
    v_fma_f32 v72, -v72, v41, v11
    v_fma_f32 v73, -v73, v41, v11
    v_fma_f32 v74, -v74, v41, v11
    v_fma_f32 v75, -v75, v41, v11
    v_fma_f32 v76, -v76, v41, v11
    v_fma_f32 v77, -v77, v41, v11
    v_fma_f32 v78, -v78, v41, v11
    v_fma_f32 v79, -v79, v41, v11
    v_exp_f32 v24, v24
    v_mfma_f32_32x32x16_bf16 v[192:207], v[108:111], v[148:151], v[192:207]
    buffer_load_dwordx4 v45, s[40:43], s68 offen offset:1024 lds
    v_exp_f32 v25, v25
    v_exp_f32 v26, v26
    v_exp_f32 v27, v27
    v_exp_f32 v28, v28
    v_exp_f32 v29, v29
    v_exp_f32 v30, v30
    v_exp_f32 v31, v31
    v_exp_f32 v72, v72
    s_cmp_lg_u32 s48, 0
    s_cbranch_scc1 L_po26
    s_mov_b32 s11, 0
    s_waitcnt vmcnt(5)
L_pc25:
    v_cmp_eq_u32 vcc, s3, v36
    s_nop 2
    s_cmp_eq_u64 vcc, -1
    s_cbranch_scc1 L_po26
    s_add_u32 s11, s11, 1
    s_cmp_ge_u32 s11, 0x40000
    s_cbranch_scc1 L_po26
    s_sleep 1
    v_and_b32 v36, 0xf0, v33
    v_lshlrev_b32 v36, 7, v36
    buffer_load_dword v36, v36, s[32:35], s17 offen offset:0 sc1
    s_waitcnt vmcnt(0)
    s_branch L_pc25
L_po26:
    s_cmp_lg_u32 s48, 0
    s_cbranch_scc1 L_po35
    s_mov_b32 s11, 0
    s_waitcnt vmcnt(4)
L_pc34:
    v_cmp_eq_u32 vcc, s3, v32
    s_nop 2
    s_cmp_eq_u64 vcc, -1
    s_cbranch_scc1 L_po35
    s_add_u32 s11, s11, 1
    s_cmp_ge_u32 s11, 0x40000
    s_cbranch_scc1 L_po35
    s_sleep 1
    v_and_b32 v32, 0x380, v33
    buffer_load_dword v32, v32, s[32:35], s81 offen offset:1028 sc1
    s_waitcnt vmcnt(0)
    s_branch L_pc34
L_po35:
    s_waitcnt vmcnt(14) lgkmcnt(0)
    s_barrier
    s_xor_b32 s12, s53, 8192
    s_add_u32 s12, s12, 147456
    v_add_u32 v43, s12, v33
    ds_read_b128 v[88:91], v43
    ds_read_b128 v[92:95], v43 offset:1024
    s_lshl1_add_u32 s14, s52, s50
    s_lshl_b32 s14, s14, 12
    s_add_u32 s14, s14, 9437184
    v_bfe_u32 v35, v33, 8, 1
    v_add_u32 v35, -1, v35
    v_lshrrev_b32 v62, 5, v33
    v_and_b32 v62, 16, v62
    v_and_or_b32 v62, v35, 32, v62
    v_bfe_i32 v63, v33, 7, 1
    v_bfi_b32 v62, v63, 64, v62
    v_add_u32 v62, 1048576, v62
    v_bfi_b32 v63, v35, v62, v33
    v_bfi_b32 v62, v35, v33, v62
    ds_read_b64_tr_b16 v[96:97], v48 offset:16384
    ds_read_b64_tr_b16 v[98:99], v48 offset:17408
    ds_read_b64_tr_b16 v[100:101], v49 offset:16384
    ds_read_b64_tr_b16 v[102:103], v49 offset:17408
    ds_read_b64_tr_b16 v[104:105], v48 offset:18432
    ds_read_b64_tr_b16 v[106:107], v48 offset:19456
    ds_read_b64_tr_b16 v[108:109], v49 offset:18432
    ds_read_b64_tr_b16 v[110:111], v49 offset:19456
    buffer_load_dwordx4 v[128:131], v62, s[32:35], s14 offen offset:0 sc1
    buffer_load_dwordx4 v[240:243], v63, s[32:35], s14 offen offset:0 sc1
    buffer_load_dwordx4 v[132:135], v62, s[32:35], s14 offen offset:1024 sc1
    buffer_load_dwordx4 v[244:247], v63, s[32:35], s14 offen offset:1024 sc1
    v_mfma_f32_32x32x16_bf16 v[224:239], v[112:115], v[152:155], v[224:239]
    buffer_load_dwordx4 v[136:139], v62, s[32:35], s14 offen offset:2048 sc1
    buffer_load_dwordx4 v[248:251], v63, s[32:35], s14 offen offset:2048 sc1
    buffer_load_dwordx4 v[140:143], v62, s[32:35], s14 offen offset:3072 sc1
    buffer_load_dwordx4 v[252:255], v63, s[32:35], s14 offen offset:3072 sc1
    v_exp_f32 v73, v73
    v_exp_f32 v74, v74
    v_exp_f32 v75, v75
    v_exp_f32 v76, v76
    v_exp_f32 v77, v77
    v_exp_f32 v78, v78
    v_exp_f32 v79, v79
    v_mfma_f32_32x32x16_bf16 v[192:207], v[116:119], v[152:155], v[192:207]
    s_add_u32 s68, s70, 4096
    buffer_load_dwordx4 v[208:211], v33, s[32:35], s68 offen sc1
    v_cvt_pk_bf16_f32 v24, v24, v25
    v_cvt_pk_bf16_f32 v25, v26, v27
    v_cvt_pk_bf16_f32 v26, v28, v29
    v_cvt_pk_bf16_f32 v27, v30, v31
    v_cvt_pk_bf16_f32 v28, v72, v73
    v_cvt_pk_bf16_f32 v29, v74, v75
    v_cvt_pk_bf16_f32 v30, v76, v77
    v_cvt_pk_bf16_f32 v31, v78, v79
    s_waitcnt lgkmcnt(0)
    v_add_f32 v80, v80, v88
    v_add_f32 v81, v81, v89
    v_add_f32 v82, v82, v90
    v_add_f32 v83, v83, v91
    v_add_f32 v84, v84, v92
    v_add_f32 v85, v85, v93
    v_add_f32 v86, v86, v94
    v_add_f32 v87, v87, v95
    s_lshl_b32 s69, s67, 5
    s_add_u32 s69, s69, s55
    s_lshl_b32 s12, s50, 10
    s_sub_u32 s69, s69, s12
    v_mul_f32 v80, v80, v41
    v_exp_f32 v168, v80
    v_mul_f32 v81, v81, v41
    v_mfma_f32_32x32x16_bf16 v[224:239], v[120:123], v[156:159], v[224:239]
    buffer_load_dwordx4 v[212:215], v33, s[32:35], s68 offen offset:1024 sc1
    s_add_u32 s68, s70, 32768
    buffer_load_dwordx4 v[216:219], v33, s[32:35], s68 offen sc1
    v_fma_f32 v160, v168, -0.5, -1.0
    v_exp_f32 v169, v81
    v_mul_f32 v82, v82, v41
    v_fma_f32 v168, v168, v160, -1.0
    v_fma_f32 v161, v169, -0.5, -1.0
    v_exp_f32 v170, v82
    v_mul_f32 v83, v83, v41
    v_rcp_f32 v168, v168
    v_fma_f32 v169, v169, v161, -1.0
    v_fma_f32 v162, v170, -0.5, -1.0
    v_exp_f32 v171, v83
    v_mul_f32 v84, v84, v41
    v_fma_f32 v80, v80, v168, v80
    v_rcp_f32 v169, v169
    v_mfma_f32_32x32x16_bf16 v[192:207], v[124:127], v[156:159], v[192:207]
    buffer_load_dwordx4 v[220:223], v33, s[32:35], s68 offen offset:1024 sc1
    v_fma_f32 v170, v170, v162, -1.0
    v_fma_f32 v163, v171, -0.5, -1.0
    v_exp_f32 v172, v84
    v_mul_f32 v85, v85, v41
    v_fma_f32 v81, v81, v169, v81
    v_rcp_f32 v170, v170
    v_fma_f32 v171, v171, v163, -1.0
    v_fma_f32 v160, v172, -0.5, -1.0
    v_exp_f32 v173, v85
    v_mul_f32 v86, v86, v41
    v_fma_f32 v82, v82, v170, v82
    v_rcp_f32 v171, v171
    v_fma_f32 v172, v172, v160, -1.0
    v_fma_f32 v161, v173, -0.5, -1.0
    s_waitcnt vmcnt(22)
    s_barrier
    ds_read_b64_tr_b16 v[112:113], v48 offset:49152
    ds_read_b64_tr_b16 v[114:115], v48 offset:50176
    ds_read_b64_tr_b16 v[116:117], v49 offset:49152
    ds_read_b64_tr_b16 v[118:119], v49 offset:50176
    ds_read_b64_tr_b16 v[120:121], v48 offset:51200
    ds_read_b64_tr_b16 v[122:123], v48 offset:52224
    ds_read_b64_tr_b16 v[124:125], v49 offset:51200
    ds_read_b64_tr_b16 v[126:127], v49 offset:52224
    s_add_u32 s68, s70, 61440
    buffer_load_dwordx4 v[144:147], v33, s[32:35], s68 offen sc1
    v_mfma_f32_32x32x16_bf16 v[224:239], v[96:99], v[176:179], v[224:239]
    buffer_load_dwordx4 v[148:151], v33, s[32:35], s68 offen offset:1024 sc1
    v_exp_f32 v174, v86
    v_mul_f32 v87, v87, v41
    v_fma_f32 v83, v83, v171, v83
    v_rcp_f32 v172, v172
    v_fma_f32 v173, v173, v161, -1.0
    v_fma_f32 v162, v174, -0.5, -1.0
    v_exp_f32 v175, v87
    v_fma_f32 v84, v84, v172, v84
    v_rcp_f32 v173, v173
    v_fma_f32 v174, v174, v162, -1.0
    v_fma_f32 v163, v175, -0.5, -1.0
    v_fma_f32 v85, v85, v173, v85
    v_rcp_f32 v174, v174
    v_mfma_f32_32x32x16_bf16 v[192:207], v[100:103], v[176:179], v[192:207]
    s_add_u32 s68, s70, 90112
    buffer_load_dwordx4 v[152:155], v33, s[32:35], s68 offen sc1
    v_fma_f32 v175, v175, v163, -1.0
    v_fma_f32 v86, v86, v174, v86
    v_rcp_f32 v175, v175
    s_nop 0
    v_fma_f32 v87, v87, v175, v87
    v_cvt_pk_bf16_f32 v160, v80, v81
    v_cvt_pk_bf16_f32 v161, v82, v83
    v_cvt_pk_bf16_f32 v162, v84, v85
    v_cvt_pk_bf16_f32 v163, v86, v87
    buffer_store_dwordx4 v[160:163], v42, s[32:35], s69 offen offset:0 sc1
    s_waitcnt vmcnt(14)
    v_cvt_pk_bf16_f32 v128, v128, v129
    v_cvt_pk_bf16_f32 v129, v130, v131
    s_waitcnt vmcnt(12)
    v_cvt_pk_bf16_f32 v130, v132, v133
    v_cvt_pk_bf16_f32 v131, v134, v135
    v_mfma_f32_32x32x16_bf16 v[224:239], v[104:107], v[180:183], v[224:239]
    buffer_load_dwordx4 v[156:159], v33, s[32:35], s68 offen offset:1024 sc1
    s_waitcnt vmcnt(11)
    v_cvt_pk_bf16_f32 v132, v136, v137
    v_cvt_pk_bf16_f32 v133, v138, v139
    s_waitcnt vmcnt(9)
    v_cvt_pk_bf16_f32 v134, v140, v141
    v_cvt_pk_bf16_f32 v135, v142, v143
    v_cvt_pk_bf16_f32 v240, v240, v241
    v_cvt_pk_bf16_f32 v241, v242, v243
    v_cvt_pk_bf16_f32 v242, v244, v245
    v_cvt_pk_bf16_f32 v243, v246, v247
    v_cvt_pk_bf16_f32 v244, v248, v249
    v_cvt_pk_bf16_f32 v245, v250, v251
    v_cvt_pk_bf16_f32 v246, v252, v253
    v_cvt_pk_bf16_f32 v247, v254, v255
    v_mfma_f32_32x32x16_bf16 v[64:79], v[128:131], v[16:19], 0
    v_mfma_f32_32x32x16_bf16 v[192:207], v[108:111], v[180:183], v[192:207]
    v_mfma_f32_32x32x16_bf16 v[0:15], v[132:135], v[20:23], 0
    v_mfma_f32_32x32x16_bf16 v[160:175], v[240:243], v[24:27], 0
    s_waitcnt lgkmcnt(0)
    s_barrier
    v_add_u32 v48, 0x10000, v48
    v_add_u32 v49, 0x10000, v49
    ds_read_b64_tr_b16 v[96:97], v48 offset:0
    ds_read_b64_tr_b16 v[98:99], v48 offset:1024
    ds_read_b64_tr_b16 v[100:101], v49 offset:0
    ds_read_b64_tr_b16 v[102:103], v49 offset:1024
    ds_read_b64_tr_b16 v[104:105], v48 offset:2048
    ds_read_b64_tr_b16 v[106:107], v48 offset:3072
    ds_read_b64_tr_b16 v[108:109], v49 offset:2048
    ds_read_b64_tr_b16 v[110:111], v49 offset:3072
    s_add_u32 m0, s53, 32768
    s_add_u32 s68, s73, 131072
    buffer_load_dwordx4 v44, s[40:43], s68 offen lds
    v_mfma_f32_32x32x16_bf16 v[224:239], v[112:115], v[184:187], v[224:239]
    buffer_load_dwordx4 v45, s[40:43], s68 offen offset:1024 lds
    v_mfma_f32_32x32x16_bf16 v[80:95], v[244:247], v[28:31], 0
    s_lshl_b32 s69, s52, 12
    s_add_u32 s69, s69, s55
    s_add_u32 s69, s69, 114688
    v_rcp_f32 v76, v76
    v_rcp_f32 v12, v12
    v_fmaak_f32 v72, v72, v76, 0x358637bd
    v_fmac_f32 v72, v8, v12
    v_rcp_f32 v72, v72
    s_nop 0
    v_mul_f32 v76, v76, v72
    v_mul_f32 v12, v12, v72
    v_mfma_f32_32x32x16_bf16 v[192:207], v[116:119], v[184:187], v[192:207]
    s_add_u32 m0, s53, 81920
    s_add_u32 s68, s73, 589824
    buffer_load_dwordx4 v44, s[40:43], s68 offen lds
    v_mul_f32 v64, v64, v76
    v_mul_f32 v65, v65, v76
    v_mul_f32 v66, v66, v76
    v_mul_f32 v67, v67, v76
    v_mul_f32 v68, v68, v76
    v_mul_f32 v69, v69, v76
    v_mul_f32 v70, v70, v76
    v_mul_f32 v71, v71, v76
    v_fmac_f32 v64, v0, v12
    v_fmac_f32 v65, v1, v12
    v_fmac_f32 v66, v2, v12
    v_fmac_f32 v67, v3, v12
    v_fmac_f32 v68, v4, v12
    v_fmac_f32 v69, v5, v12
    v_fmac_f32 v70, v6, v12
    v_fmac_f32 v71, v7, v12
    v_cvt_pk_bf16_f32 v64, v64, v65
    v_cvt_pk_bf16_f32 v65, v66, v67
    v_mfma_f32_32x32x16_bf16 v[224:239], v[120:123], v[188:191], v[224:239]
    buffer_load_dwordx4 v45, s[40:43], s68 offen offset:1024 lds
    v_cvt_pk_bf16_f32 v66, v68, v69
    v_cvt_pk_bf16_f32 v67, v70, v71
    buffer_store_dwordx4 v[64:67], v42, s[32:35], s69 offen offset:0 sc1
    v_rcp_f32 v164, v164
    v_rcp_f32 v84, v84
    v_fmaak_f32 v160, v160, v164, 0x358637bd
    v_fmac_f32 v160, v80, v84
    v_rcp_f32 v160, v160
    s_nop 0
    v_mul_f32 v164, v164, v160
    v_mul_f32 v84, v84, v160
    v_mul_f32 v168, v168, v164
    v_mul_f32 v169, v169, v164
    v_mul_f32 v170, v170, v164
    v_mul_f32 v171, v171, v164
    v_mul_f32 v172, v172, v164
    v_mfma_f32_32x32x16_bf16 v[192:207], v[124:127], v[188:191], v[192:207]
    v_mul_f32 v173, v173, v164
    v_mul_f32 v174, v174, v164
    v_mul_f32 v175, v175, v164
    v_fmac_f32 v168, v88, v84
    v_fmac_f32 v169, v89, v84
    v_fmac_f32 v170, v90, v84
    v_fmac_f32 v171, v91, v84
    v_fmac_f32 v172, v92, v84
    v_fmac_f32 v173, v93, v84
    v_fmac_f32 v174, v94, v84
    v_fmac_f32 v175, v95, v84
    v_cvt_pk_bf16_f32 v168, v168, v169
    v_cvt_pk_bf16_f32 v169, v170, v171
    v_cvt_pk_bf16_f32 v170, v172, v173
    v_cvt_pk_bf16_f32 v171, v174, v175
    buffer_store_dwordx4 v[168:171], v42, s[32:35], s69 offen offset:1024 sc1
    s_waitcnt vmcnt(7) lgkmcnt(0)
    s_barrier
    s_cmp_lg_u32 s48, 0
    s_cbranch_scc1 L_w023
    v_mov_b32 v61, s3
    buffer_store_dword v61, off, s[32:35], s16 offset:8 sc1
L_w023:
    v_add_u32 v48, 0x8000, v48
    v_add_u32 v49, 0x8000, v49
    ds_read_b64_tr_b16 v[112:113], v48 offset:32768
    ds_read_b64_tr_b16 v[114:115], v48 offset:33792
    ds_read_b64_tr_b16 v[116:117], v49 offset:32768
    ds_read_b64_tr_b16 v[118:119], v49 offset:33792
    ds_read_b64_tr_b16 v[120:121], v48 offset:34816
    ds_read_b64_tr_b16 v[122:123], v48 offset:35840
    ds_read_b64_tr_b16 v[124:125], v49 offset:34816
    ds_read_b64_tr_b16 v[126:127], v49 offset:35840
    s_add_u32 m0, s53, 0
    s_add_u32 s68, s73, 1048576
    buffer_load_dwordx4 v44, s[40:43], s68 offen lds
    v_mfma_f32_32x32x16_bf16 v[224:239], v[96:99], v[208:211], v[224:239]
    buffer_load_dwordx4 v45, s[40:43], s68 offen offset:1024 lds
    v_mfma_f32_32x32x16_bf16 v[192:207], v[100:103], v[208:211], v[192:207]
    s_add_u32 m0, s53, 16384
    s_add_u32 s68, s73, 1507328
    buffer_load_dwordx4 v44, s[40:43], s68 offen lds
    v_mfma_f32_32x32x16_bf16 v[224:239], v[104:107], v[212:215], v[224:239]
    buffer_load_dwordx4 v45, s[40:43], s68 offen offset:1024 lds
    v_mfma_f32_32x32x16_bf16 v[192:207], v[108:111], v[212:215], v[192:207]
    s_waitcnt vmcnt(4) lgkmcnt(0)
    s_barrier
    s_cmp_lg_u32 s48, 0
    s_cbranch_scc1 L_w024
    v_mov_b32 v36, s3
    buffer_store_dword v36, off, s[32:35], s16 offset:12 sc1
L_w024:
    ds_read_b64_tr_b16 v[96:97], v48 offset:0
    ds_read_b64_tr_b16 v[98:99], v48 offset:1024
    ds_read_b64_tr_b16 v[100:101], v49 offset:0
    ds_read_b64_tr_b16 v[102:103], v49 offset:1024
    ds_read_b64_tr_b16 v[104:105], v48 offset:2048
    ds_read_b64_tr_b16 v[106:107], v48 offset:3072
    ds_read_b64_tr_b16 v[108:109], v49 offset:2048
    ds_read_b64_tr_b16 v[110:111], v49 offset:3072
    v_and_b32 v32, 0x380, v33
    buffer_load_dword v32, v32, s[32:35], s81 offen offset:8 sc1
    v_mfma_f32_32x32x16_bf16 v[224:239], v[112:115], v[216:219], v[224:239]
    s_add_u32 m0, s53, 131072
    s_add_u32 s68, s74, 196608
    buffer_load_dwordx4 v44, s[40:43], s68 offen lds
    v_mfma_f32_32x32x16_bf16 v[192:207], v[116:119], v[216:219], v[192:207]
    buffer_load_dwordx4 v45, s[40:43], s68 offen offset:1024 lds
    v_mfma_f32_32x32x16_bf16 v[224:239], v[120:123], v[220:223], v[224:239]
    s_add_u32 m0, s53, 49152
    s_add_u32 s68, s74, 1114112
    buffer_load_dwordx4 v44, s[40:43], s68 offen lds
    v_mfma_f32_32x32x16_bf16 v[192:207], v[124:127], v[220:223], v[192:207]
    buffer_load_dwordx4 v45, s[40:43], s68 offen offset:1024 lds
    s_cmp_lg_u32 s48, 0
    s_cbranch_scc1 L_po37
    s_mov_b32 s11, 0
    s_waitcnt vmcnt(4)
L_pc36:
    v_cmp_eq_u32 vcc, s3, v32
    s_nop 2
    s_cmp_eq_u64 vcc, -1
    s_cbranch_scc1 L_po37
    s_add_u32 s11, s11, 1
    s_cmp_ge_u32 s11, 0x40000
    s_cbranch_scc1 L_po37
    s_sleep 1
    v_and_b32 v32, 0x380, v33
    buffer_load_dword v32, v32, s[32:35], s81 offen offset:8 sc1
    s_waitcnt vmcnt(0)
    s_branch L_pc36
L_po37:
    s_waitcnt lgkmcnt(0)
    s_barrier
    ds_read_b64_tr_b16 v[112:113], v48 offset:16384
    ds_read_b64_tr_b16 v[114:115], v48 offset:17408
    ds_read_b64_tr_b16 v[116:117], v49 offset:16384
    ds_read_b64_tr_b16 v[118:119], v49 offset:17408
    ds_read_b64_tr_b16 v[120:121], v48 offset:18432
    ds_read_b64_tr_b16 v[122:123], v48 offset:19456
    ds_read_b64_tr_b16 v[124:125], v49 offset:18432
    ds_read_b64_tr_b16 v[126:127], v49 offset:19456
    s_add_u32 s68, s70, 8192
    buffer_load_dwordx4 v[176:179], v33, s[32:35], s68 offen sc1
    v_mfma_f32_32x32x16_bf16 v[224:239], v[96:99], v[144:147], v[224:239]
    buffer_load_dwordx4 v[180:183], v33, s[32:35], s68 offen offset:1024 sc1
    v_mfma_f32_32x32x16_bf16 v[192:207], v[100:103], v[144:147], v[192:207]
    s_add_u32 s68, s70, 36864
    buffer_load_dwordx4 v[128:131], v33, s[32:35], s68 offen sc1
    v_mfma_f32_32x32x16_bf16 v[224:239], v[104:107], v[148:151], v[224:239]
    buffer_load_dwordx4 v[132:135], v33, s[32:35], s68 offen offset:1024 sc1
    v_mfma_f32_32x32x16_bf16 v[192:207], v[108:111], v[148:151], v[192:207]
    s_waitcnt lgkmcnt(0)
    s_barrier
    v_add_u32 v48, 0xfffe8000, v48
    v_add_u32 v49, 0xfffe8000, v49
    ds_read_b64_tr_b16 v[96:97], v48 offset:32768
    ds_read_b64_tr_b16 v[98:99], v48 offset:33792
    ds_read_b64_tr_b16 v[100:101], v49 offset:32768
    ds_read_b64_tr_b16 v[102:103], v49 offset:33792
    ds_read_b64_tr_b16 v[104:105], v48 offset:34816
    ds_read_b64_tr_b16 v[106:107], v48 offset:35840
    ds_read_b64_tr_b16 v[108:109], v49 offset:34816
    ds_read_b64_tr_b16 v[110:111], v49 offset:35840
    s_add_u32 s68, s70, 65536
    buffer_load_dwordx4 v[136:139], v33, s[32:35], s68 offen sc1
    v_mfma_f32_32x32x16_bf16 v[224:239], v[112:115], v[152:155], v[224:239]
    buffer_load_dwordx4 v[140:143], v33, s[32:35], s68 offen offset:1024 sc1
    v_mfma_f32_32x32x16_bf16 v[192:207], v[116:119], v[152:155], v[192:207]
    s_add_u32 s68, s70, 94208
    buffer_load_dwordx4 v[160:163], v33, s[32:35], s68 offen sc1
    v_mfma_f32_32x32x16_bf16 v[224:239], v[120:123], v[156:159], v[224:239]
    buffer_load_dwordx4 v[164:167], v33, s[32:35], s68 offen offset:1024 sc1
    v_mfma_f32_32x32x16_bf16 v[192:207], v[124:127], v[156:159], v[192:207]
    s_waitcnt lgkmcnt(0)
    s_barrier
    v_add_u32 v48, 0x10000, v48
    v_add_u32 v49, 0x10000, v49
    ds_read_b64_tr_b16 v[112:113], v48 offset:16384
    ds_read_b64_tr_b16 v[114:115], v48 offset:17408
    ds_read_b64_tr_b16 v[116:117], v49 offset:16384
    ds_read_b64_tr_b16 v[118:119], v49 offset:17408
    ds_read_b64_tr_b16 v[120:121], v48 offset:18432
    ds_read_b64_tr_b16 v[122:123], v48 offset:19456
    ds_read_b64_tr_b16 v[124:125], v49 offset:18432
    ds_read_b64_tr_b16 v[126:127], v49 offset:19456
    s_add_u32 m0, s53, 65536
    s_add_u32 s68, s75, 0
    buffer_load_dwordx4 v44, s[44:47], s68 offen lds
    s_waitcnt vmcnt(7)
    v_mfma_f32_32x32x16_bf16 v[224:239], v[96:99], v[176:179], v[224:239]
    buffer_load_dwordx4 v45, s[44:47], s68 offen offset:1024 lds
    v_mfma_f32_32x32x16_bf16 v[192:207], v[100:103], v[176:179], v[192:207]
    s_add_u32 m0, s53, 32768
    s_add_u32 s68, s75, 131072
    buffer_load_dwordx4 v44, s[44:47], s68 offen lds
    v_mfma_f32_32x32x16_bf16 v[224:239], v[104:107], v[180:183], v[224:239]
    buffer_load_dwordx4 v45, s[44:47], s68 offen offset:1024 lds
    v_mfma_f32_32x32x16_bf16 v[192:207], v[108:111], v[180:183], v[192:207]
    s_waitcnt lgkmcnt(0)
    s_barrier
    v_add_u32 v48, 0xffff0000, v48
    v_add_u32 v49, 0xffff0000, v49
    ds_read_b64_tr_b16 v[96:97], v48 offset:0
    ds_read_b64_tr_b16 v[98:99], v48 offset:1024
    ds_read_b64_tr_b16 v[100:101], v49 offset:0
    ds_read_b64_tr_b16 v[102:103], v49 offset:1024
    ds_read_b64_tr_b16 v[104:105], v48 offset:2048
    ds_read_b64_tr_b16 v[106:107], v48 offset:3072
    ds_read_b64_tr_b16 v[108:109], v49 offset:2048
    ds_read_b64_tr_b16 v[110:111], v49 offset:3072
    v_and_b32 v32, 0x380, v33
    buffer_load_dword v32, v32, s[32:35], s81 offen offset:1032 sc1
    s_waitcnt vmcnt(9)
    v_mfma_f32_32x32x16_bf16 v[224:239], v[112:115], v[128:131], v[224:239]
    s_add_u32 m0, s53, 81920
    s_add_u32 s68, s75, 262144
    buffer_load_dwordx4 v44, s[44:47], s68 offen lds
    v_mfma_f32_32x32x16_bf16 v[192:207], v[116:119], v[128:131], v[192:207]
    v_lshrrev_b32 v56, 7, v33
    v_and_b32 v57, 0x70, v33
    v_lshl_add_u32 v56, v56, 10, v57
    v_mfma_f32_32x32x16_bf16 v[224:239], v[120:123], v[132:135], v[224:239]
    buffer_load_dwordx4 v45, s[44:47], s68 offen offset:1024 lds
    buffer_load_dwordx4 v[52:55], v56, s[24:27], s80 offen
    v_mfma_f32_32x32x16_bf16 v[192:207], v[124:127], v[132:135], v[192:207]
    s_cmp_lg_u32 s48, 0
    s_cbranch_scc1 L_po39
    s_mov_b32 s11, 0
    s_waitcnt vmcnt(3)
L_pc38:
    v_cmp_eq_u32 vcc, s3, v32
    s_nop 2
    s_cmp_eq_u64 vcc, -1
    s_cbranch_scc1 L_po39
    s_add_u32 s11, s11, 1
    s_cmp_ge_u32 s11, 0x40000
    s_cbranch_scc1 L_po39
    s_sleep 1
    v_and_b32 v32, 0x380, v33
    buffer_load_dword v32, v32, s[32:35], s81 offen offset:1032 sc1
    s_waitcnt vmcnt(0)
    s_branch L_pc38
L_po39:
    s_waitcnt lgkmcnt(0)
    s_barrier
    ds_read_b64_tr_b16 v[112:113], v48 offset:16384
    ds_read_b64_tr_b16 v[114:115], v48 offset:17408
    ds_read_b64_tr_b16 v[116:117], v49 offset:16384
    ds_read_b64_tr_b16 v[118:119], v49 offset:17408
    ds_read_b64_tr_b16 v[120:121], v48 offset:18432
    ds_read_b64_tr_b16 v[122:123], v48 offset:19456
    ds_read_b64_tr_b16 v[124:125], v49 offset:18432
    ds_read_b64_tr_b16 v[126:127], v49 offset:19456
    s_add_u32 s68, s71, 12288
    buffer_load_dwordx4 v[168:171], v33, s[32:35], s68 offen sc1
    s_waitcnt vmcnt(11)
    v_mfma_f32_32x32x16_bf16 v[224:239], v[96:99], v[136:139], v[224:239]
    buffer_load_dwordx4 v[172:175], v33, s[32:35], s68 offen offset:1024 sc1
    v_mfma_f32_32x32x16_bf16 v[192:207], v[100:103], v[136:139], v[192:207]
    s_add_u32 s68, s71, 69632
    buffer_load_dwordx4 v[184:187], v33, s[32:35], s68 offen sc1
    v_mfma_f32_32x32x16_bf16 v[224:239], v[104:107], v[140:143], v[224:239]
    buffer_load_dwordx4 v[188:191], v33, s[32:35], s68 offen offset:1024 sc1
    v_mfma_f32_32x32x16_bf16 v[192:207], v[108:111], v[140:143], v[192:207]
    v_add_u32 v48, 0x18000, v48
    v_add_u32 v49, 0x18000, v49
    ds_read_b64_tr_b16 v[96:97], v48 offset:32768
    ds_read_b64_tr_b16 v[98:99], v48 offset:33792
    ds_read_b64_tr_b16 v[100:101], v49 offset:32768
    ds_read_b64_tr_b16 v[102:103], v49 offset:33792
    ds_read_b64_tr_b16 v[104:105], v48 offset:34816
    ds_read_b64_tr_b16 v[106:107], v48 offset:35840
    ds_read_b64_tr_b16 v[108:109], v49 offset:34816
    ds_read_b64_tr_b16 v[110:111], v49 offset:35840
    s_add_u32 m0, s53, 0
    s_add_u32 s68, s75, 393216
    buffer_load_dwordx4 v44, s[44:47], s68 offen lds
    s_waitcnt vmcnt(13) lgkmcnt(8)
    v_mfma_f32_32x32x16_bf16 v[224:239], v[112:115], v[160:163], v[224:239]
    v_lshrrev_b32 v1, 5, v33
    v_and_b32 v1, 16, v1
    v_and_b32 v2, 0xf0, v33
    v_xor_b32 v1, v1, v2
    v_and_b32 v2, 0x1f0, v33
    v_lshl_add_u32 v1, v2, 4, v1
    v_mfma_f32_32x32x16_bf16 v[192:207], v[116:119], v[160:163], v[192:207]
    buffer_load_dwordx4 v45, s[44:47], s68 offen offset:1024 lds
    s_lshl1_add_u32 s12, s49, s50
    s_add_u32 s12, s12, 12
    v_lshl_add_u32 v0, s12, 13, v1
    v_xor_b32 v1, 32, v0
    v_mfma_f32_32x32x16_bf16 v[224:239], v[120:123], v[164:167], v[224:239]
    v_xor_b32 v2, 64, v0
    v_xor_b32 v3, 96, v0
    v_xor_b32 v4, 128, v0
    v_xor_b32 v5, 160, v0
    v_xor_b32 v6, 192, v0
    v_xor_b32 v7, 224, v0
    v_mfma_f32_32x32x16_bf16 v[192:207], v[124:127], v[164:167], v[192:207]
    v_lshrrev_b32 v8, 7, v33
    v_lshl_add_u32 v8, s48, 3, v8
    v_add_u32 v48, 0xfffe8000, v48
    v_add_u32 v49, 0xfffe8000, v49
    ds_read_b64_tr_b16 v[112:113], v48 offset:49152
    ds_read_b64_tr_b16 v[114:115], v48 offset:50176
    ds_read_b64_tr_b16 v[116:117], v49 offset:49152
    ds_read_b64_tr_b16 v[118:119], v49 offset:50176
    ds_read_b64_tr_b16 v[120:121], v48 offset:51200
    ds_read_b64_tr_b16 v[122:123], v48 offset:52224
    ds_read_b64_tr_b16 v[124:125], v49 offset:51200
    ds_read_b64_tr_b16 v[126:127], v49 offset:52224
    s_waitcnt vmcnt(9)
    v_and_b32 v32, 0x380, v33
    buffer_load_dword v32, v32, s[32:35], s81 offen offset:1036 sc1
    s_waitcnt vmcnt(5) lgkmcnt(8)
    v_mfma_f32_32x32x16_bf16 v[224:239], v[96:99], v[168:171], v[224:239]
    v_bfe_u32 v9, v33, 4, 3
    v_lshlrev_b32 v9, 1, v9
    v_and_b32 v10, 15, v8
    v_xor_b32 v9, v9, v10
    v_lshlrev_b32 v9, 4, v9
    v_mfma_f32_32x32x16_bf16 v[192:207], v[100:103], v[168:171], v[192:207]
    v_lshl_add_u32 v8, v8, 8, v9
    v_add_u32 v8, 98304, v8
    v_xor_b32 v9, 16, v8
    v_mov_b32 v10, 0x3fb8aa3b
    v_lshlrev_b32 v24, 16, v52
    v_mfma_f32_32x32x16_bf16 v[224:239], v[104:107], v[172:175], v[224:239]
    v_and_b32 v25, 0xffff0000, v52
    v_lshlrev_b32 v26, 16, v53
    v_and_b32 v27, 0xffff0000, v53
    v_lshlrev_b32 v28, 16, v54
    v_and_b32 v29, 0xffff0000, v54
    v_mfma_f32_32x32x16_bf16 v[192:207], v[108:111], v[172:175], v[192:207]
    v_lshlrev_b32 v30, 16, v55
    v_and_b32 v31, 0xffff0000, v55
    s_cmp_lg_u32 s48, 0
    s_cbranch_scc1 L_po41
    s_mov_b32 s11, 0
    s_waitcnt vmcnt(0)
L_pc40:
    v_cmp_eq_u32 vcc, s3, v32
    s_nop 2
    s_cmp_eq_u64 vcc, -1
    s_cbranch_scc1 L_po41
    s_add_u32 s11, s11, 1
    s_cmp_ge_u32 s11, 0x40000
    s_cbranch_scc1 L_po41
    s_sleep 1
    v_and_b32 v32, 0x380, v33
    buffer_load_dword v32, v32, s[32:35], s81 offen offset:1036 sc1
    s_waitcnt vmcnt(0)
    s_branch L_pc40
L_po41:
    s_waitcnt lgkmcnt(0)
    s_barrier
    s_add_u32 s68, s72, 0
    buffer_load_dwordx4 v[240:243], v33, s[32:35], s68 offen sc1
    buffer_load_dwordx4 v[244:247], v33, s[32:35], s68 offen offset:1024 sc1
    s_waitcnt vmcnt(5)
    v_mfma_f32_32x32x16_bf16 v[224:239], v[112:115], v[184:187], v[224:239]
    v_mfma_f32_32x32x16_bf16 v[224:239], v[120:123], v[188:191], v[224:239]
    v_add_u32 v48, 0x10000, v48
    v_add_u32 v49, 0x10000, v49
    ds_read_b64_tr_b16 v[96:97], v48 offset:0
    ds_read_b64_tr_b16 v[98:99], v48 offset:1024
    ds_read_b64_tr_b16 v[100:101], v49 offset:0
    ds_read_b64_tr_b16 v[102:103], v49 offset:1024
    v_mfma_f32_32x32x16_bf16 v[192:207], v[116:119], v[184:187], v[192:207]
    v_mfma_f32_32x32x16_bf16 v[192:207], v[124:127], v[188:191], v[192:207]
    ds_read_b64_tr_b16 v[104:105], v48 offset:2048
    ds_read_b64_tr_b16 v[106:107], v48 offset:3072
    ds_read_b64_tr_b16 v[108:109], v49 offset:2048
    ds_read_b64_tr_b16 v[110:111], v49 offset:3072
    s_add_u32 s68, s72, 8192
    buffer_load_dwordx4 v[248:251], v33, s[32:35], s68 offen sc1
    ds_write_b128 v0, v[224:227]
    buffer_load_dwordx4 v[252:255], v33, s[32:35], s68 offen offset:1024 sc1
    ds_write_b128 v1, v[228:231]
    s_add_u32 s68, s72, 16384
    buffer_load_dwordx4 v[208:211], v33, s[32:35], s68 offen sc1
    ds_write_b128 v2, v[232:235]
    buffer_load_dwordx4 v[212:215], v33, s[32:35], s68 offen offset:1024 sc1
    ds_write_b128 v3, v[236:239]
    s_add_u32 s68, s72, 24576
    buffer_load_dwordx4 v[216:219], v33, s[32:35], s68 offen sc1
    ds_write_b128 v4, v[192:195]
    buffer_load_dwordx4 v[220:223], v33, s[32:35], s68 offen offset:1024 sc1
    ds_write_b128 v5, v[196:199]
    ds_write_b128 v6, v[200:203]
    ds_write_b128 v7, v[204:207]
    s_waitcnt lgkmcnt(0)
    s_barrier
    ds_read_b128 v[224:227], v8 offset:0
    ds_read_b128 v[228:231], v9 offset:0
    ds_read_b128 v[232:235], v8 offset:16384
    ds_read_b128 v[236:239], v9 offset:16384
    ds_read_b128 v[192:195], v8 offset:32768
    ds_read_b128 v[196:199], v9 offset:32768
    ds_read_b128 v[200:203], v8 offset:49152
    ds_read_b128 v[204:207], v9 offset:49152
    v_add_u32 v48, 0xffff0000, v48
    v_add_u32 v49, 0xffff0000, v49
    ds_read_b64_tr_b16 v[112:113], v48 offset:32768
    ds_read_b64_tr_b16 v[114:115], v48 offset:33792
    ds_read_b64_tr_b16 v[116:117], v49 offset:32768
    ds_read_b64_tr_b16 v[118:119], v49 offset:33792
    ds_read_b64_tr_b16 v[120:121], v48 offset:34816
    ds_read_b64_tr_b16 v[122:123], v48 offset:35840
    ds_read_b64_tr_b16 v[124:125], v49 offset:34816
    ds_read_b64_tr_b16 v[126:127], v49 offset:35840
    s_waitcnt vmcnt(6)
    v_mfma_f32_32x32x16_bf16 v[64:79], v[96:99], v[240:243], 0
    s_waitcnt lgkmcnt(13)
    v_add_f32 v224, v224, v232
    v_add_f32 v225, v225, v233
    v_add_f32 v226, v226, v234
    v_add_f32 v227, v227, v235
    s_waitcnt lgkmcnt(10)
    v_add_f32 v228, v228, v236
    v_add_f32 v229, v229, v237
    v_add_f32 v230, v230, v238
    v_add_f32 v231, v231, v239
    s_waitcnt lgkmcnt(7)
    v_add_f32 v192, v192, v200
    v_add_f32 v193, v193, v201
    v_add_f32 v194, v194, v202
    v_add_f32 v195, v195, v203
    v_add_f32 v196, v196, v204
    v_add_f32 v197, v197, v205
    v_add_f32 v198, v198, v206
    v_add_f32 v199, v199, v207
    v_add_f32 v224, v224, v192
    v_add_f32 v225, v225, v193
    v_add_f32 v226, v226, v194
    v_mfma_f32_32x32x16_bf16 v[80:95], v[100:103], v[240:243], 0
    v_add_f32 v227, v227, v195
    v_add_f32 v228, v228, v196
    v_add_f32 v229, v229, v197
    v_add_f32 v230, v230, v198
    v_add_f32 v231, v231, v199
    v_exp_f32_e64 v16, -v224
    v_exp_f32_e64 v17, -v225
    v_exp_f32_e64 v18, -v226
    v_exp_f32_e64 v19, -v227
    v_exp_f32_e64 v20, -v228
    v_exp_f32_e64 v21, -v229
    v_exp_f32_e64 v22, -v230
    v_mfma_f32_32x32x16_bf16 v[64:79], v[104:107], v[244:247], v[64:79]
    v_exp_f32_e64 v23, -v231
    v_fma_f32 v16, v16, v10, v10
    v_fma_f32 v17, v17, v10, v10
    v_fma_f32 v18, v18, v10, v10
    v_fma_f32 v19, v19, v10, v10
    v_fma_f32 v20, v20, v10, v10
    v_fma_f32 v21, v21, v10, v10
    v_fma_f32 v22, v22, v10, v10
    v_fma_f32 v23, v23, v10, v10
    v_rcp_f32 v16, v16
    v_rcp_f32 v17, v17
    v_rcp_f32 v18, v18
    v_rcp_f32 v19, v19
    v_mfma_f32_32x32x16_bf16 v[80:95], v[108:111], v[244:247], v[80:95]
    v_rcp_f32 v20, v20
    v_rcp_f32 v21, v21
    v_rcp_f32 v22, v22
    v_rcp_f32 v23, v23
    v_mul_f32 v16, v16, v224
    v_mul_f32 v17, v17, v225
    v_mul_f32 v18, v18, v226
    v_mul_f32 v19, v19, v227
    v_mul_f32 v20, v20, v228
    v_mul_f32 v21, v21, v229
    v_mul_f32 v22, v22, v230
    v_mul_f32 v23, v23, v231
    s_waitcnt lgkmcnt(0)
    s_barrier
    v_add_u32 v48, 0x10000, v48
    v_add_u32 v49, 0x10000, v49
    ds_read_b64_tr_b16 v[96:97], v48 offset:16384
    ds_read_b64_tr_b16 v[98:99], v48 offset:17408
    ds_read_b64_tr_b16 v[100:101], v48 offset:18432
    ds_read_b64_tr_b16 v[102:103], v48 offset:19456
    s_waitcnt vmcnt(4)
    v_mfma_f32_32x32x16_bf16 v[64:79], v[112:115], v[248:251], v[64:79]
    v_add_u32 v48, 0xffff0000, v48
    v_add_u32 v49, 0xffff0000, v49
    ds_read_b64_tr_b16 v[104:105], v48 offset:0
    ds_read_b64_tr_b16 v[106:107], v48 offset:1024
    ds_read_b64_tr_b16 v[108:109], v48 offset:2048
    ds_read_b64_tr_b16 v[110:111], v48 offset:3072
    v_mfma_f32_32x32x16_bf16 v[64:79], v[120:123], v[252:255], v[64:79]
    v_add_u32 v48, 0x10000, v48
    v_add_u32 v49, 0x10000, v49
    ds_read_b64_tr_b16 v[112:113], v49 offset:16384
    ds_read_b64_tr_b16 v[114:115], v49 offset:17408
    s_waitcnt vmcnt(2) lgkmcnt(8)
    v_mfma_f32_32x32x16_bf16 v[64:79], v[96:99], v[208:211], v[64:79]
    ds_read_b64_tr_b16 v[120:121], v49 offset:18432
    ds_read_b64_tr_b16 v[122:123], v49 offset:19456
    s_waitcnt lgkmcnt(8)
    v_mfma_f32_32x32x16_bf16 v[64:79], v[100:103], v[212:215], v[64:79]
    v_add_u32 v48, 0xffff0000, v48
    v_add_u32 v49, 0xffff0000, v49
    ds_read_b64_tr_b16 v[96:97], v49 offset:0
    ds_read_b64_tr_b16 v[98:99], v49 offset:1024
    s_waitcnt vmcnt(0) lgkmcnt(8)
    v_mfma_f32_32x32x16_bf16 v[64:79], v[104:107], v[216:219], v[64:79]
    ds_read_b64_tr_b16 v[100:101], v49 offset:2048
    ds_read_b64_tr_b16 v[102:103], v49 offset:3072
    s_waitcnt lgkmcnt(8)
    v_mfma_f32_32x32x16_bf16 v[64:79], v[108:111], v[220:223], v[64:79]
    v_mfma_f32_32x32x16_bf16 v[80:95], v[116:119], v[248:251], v[80:95]
    v_mfma_f32_32x32x16_bf16 v[80:95], v[124:127], v[252:255], v[80:95]
    s_waitcnt lgkmcnt(6)
    v_mfma_f32_32x32x16_bf16 v[80:95], v[112:115], v[208:211], v[80:95]
    s_nop 7
    ds_write_b128 v0, v[64:67]
    s_waitcnt lgkmcnt(5)
    v_mfma_f32_32x32x16_bf16 v[80:95], v[120:123], v[212:215], v[80:95]
    ds_write_b128 v1, v[68:71]
    s_waitcnt lgkmcnt(4)
    v_mfma_f32_32x32x16_bf16 v[80:95], v[96:99], v[216:219], v[80:95]
    ds_write_b128 v2, v[72:75]
    s_waitcnt lgkmcnt(3)
    v_mfma_f32_32x32x16_bf16 v[80:95], v[100:103], v[220:223], v[80:95]
    ds_write_b128 v3, v[76:79]
    s_nop 10
    ds_write_b128 v4, v[80:83]
    ds_write_b128 v5, v[84:87]
    ds_write_b128 v6, v[88:91]
    ds_write_b128 v7, v[92:95]
    s_waitcnt lgkmcnt(0)
    s_barrier
    ds_read_b128 v[224:227], v8 offset:0
    ds_read_b128 v[228:231], v9 offset:0
    ds_read_b128 v[232:235], v8 offset:16384
    ds_read_b128 v[236:239], v9 offset:16384
    ds_read_b128 v[192:195], v8 offset:32768
    ds_read_b128 v[196:199], v9 offset:32768
    ds_read_b128 v[200:203], v8 offset:49152
    ds_read_b128 v[204:207], v9 offset:49152
    s_waitcnt lgkmcnt(5)
    v_pk_add_f32 v[224:225], v[224:225], v[232:233]
    v_pk_add_f32 v[226:227], v[226:227], v[234:235]
    s_waitcnt lgkmcnt(4)
    v_pk_add_f32 v[228:229], v[228:229], v[236:237]
    v_pk_add_f32 v[230:231], v[230:231], v[238:239]
    s_waitcnt lgkmcnt(1)
    v_pk_add_f32 v[192:193], v[192:193], v[200:201]
    v_pk_add_f32 v[194:195], v[194:195], v[202:203]
    s_waitcnt lgkmcnt(0)
    v_pk_add_f32 v[196:197], v[196:197], v[204:205]
    v_pk_add_f32 v[198:199], v[198:199], v[206:207]
    v_pk_add_f32 v[224:225], v[224:225], v[192:193]
    v_pk_add_f32 v[226:227], v[226:227], v[194:195]
    v_pk_add_f32 v[228:229], v[228:229], v[196:197]
    v_pk_add_f32 v[230:231], v[230:231], v[198:199]
    v_pk_fma_f32 v[24:25], v[224:225], v[16:17], v[24:25]
    v_pk_fma_f32 v[26:27], v[226:227], v[18:19], v[26:27]
    v_pk_fma_f32 v[28:29], v[228:229], v[20:21], v[28:29]
    v_pk_fma_f32 v[30:31], v[230:231], v[22:23], v[30:31]
    v_cvt_pk_bf16_f32 v16, v24, v25
    v_cvt_pk_bf16_f32 v17, v26, v27
    v_cvt_pk_bf16_f32 v18, v28, v29
    v_cvt_pk_bf16_f32 v19, v30, v31
    buffer_store_dwordx4 v[16:19], v56, s[76:79], s80 offen sc1
L_end:
    s_endpgm
.fill (33024 - (. - recurrent_scan__linear_kernel_hedgehog__dense_activation_mish__prompt_kernel)) / 4, 4, 0xbf800000
.section .rodata,"a"
.p2align 6
.amdhsa_kernel recurrent_scan__linear_kernel_hedgehog__dense_activation_mish__prompt_kernel
  .amdhsa_next_free_vgpr 256
  .amdhsa_next_free_sgpr 102
  .amdhsa_accum_offset 256
  .amdhsa_group_segment_fixed_size 0
  .amdhsa_kernarg_size 88
  .amdhsa_user_sgpr_count 2
  .amdhsa_user_sgpr_kernarg_segment_ptr 1
  .amdhsa_system_sgpr_workgroup_id_x 1
.end_amdhsa_kernel
```
